```python
import torch

def _softmax(x, axis=-1):
    return torch.softmax(x, dim=axis)

def _gelu(x):
    return torch.nn.functional.gelu(x, approximate='tanh')

def _silu(x):
    return torch.nn.functional.silu(x)

def _sigmoid(x):
    return torch.sigmoid(x)

def _layernorm(x, axis=-1, eps=1e-05):
    m = x.mean(dim=axis, keepdim=True)
    v = x.var(dim=axis, keepdim=True, unbiased=False)
    return (x - m) / torch.sqrt(v + eps)

def _scatter_add(tgt, idx, src, axis=0):
    return tgt.clone().index_add_(axis, idx, src)

def _segment_sum(src, seg, n):
    out = torch.zeros((n,) + src.shape[1:], dtype=src.dtype)
    return out.index_add_(0, seg, src)

def _pad(x, pw):
    flat = tuple((v for pair in reversed(pw) for v in pair))
    return torch.nn.functional.pad(x, flat)
kernel_name = 'gather_scatter__tensor_product_equiv_mace__graph'

def setup_inputs():

    _w = lambda a: (lambda t: t.to(torch.bfloat16) if t.is_floating_point() else t)(torch.as_tensor(a))
    N, deg = (10000, 16)
    Lmax, C, De = (1, 128, 16)
    M = (Lmax + 1) ** 2
    E = N * deg
    src = (lambda lo, hi, *s: torch.randint(lo, hi, s))(0, N, E).to(torch.int64)
    dst = (lambda lo, hi, *s: torch.randint(lo, hi, s))(0, N, E).to(torch.int64)
    r = (lambda *s: torch.randn(*s, dtype=torch.bfloat16) * 0.05)(E, 3).to(float)
    r = r / (torch.linalg.norm(r, dim=-1, keepdim=True).to(float) + 1e-06)
    rx, ry, rz = (r[:, 0].clone(), r[:, 1].clone(), r[:, 2].clone())
    x2, y2, z2 = (rx * rx, ry * ry, rz * rz)
    sh_list = [torch.ones_like(rx), rx, ry, rz, rx * ry, ry * rz, 2.0 * z2 - x2 - y2, rx * rz, x2 - y2, ry * (3.0 * x2 - y2), rx * ry * rz, ry * (4.0 * z2 - x2 - y2), rz * (2.0 * z2 - 3.0 * x2 - 3.0 * y2), rx * (4.0 * z2 - x2 - y2), rz * (x2 - y2), rx * (x2 - 3.0 * y2)]
    sh16 = torch.stack(sh_list, dim=-1).to(float)
    pad = max(0, M - 16)
    sh_full = torch.cat([sh16, torch.zeros((E, pad), dtype=float)], dim=-1)[:, :M]
    cg = ((lambda *s: torch.randn(*s, dtype=torch.bfloat16) * 0.05)(M, M, M) * (1.0 / float(M))).to(float)
    return {'x': _w(((lambda *s: torch.randn(*s, dtype=torch.bfloat16) * 0.05)(N, M, C) * 0.3).to(float)), 'src': _w(src), 'dst': _w(dst), 'sh': _w(sh_full.to(float)), 'edge_attr': _w(((lambda *s: torch.randn(*s, dtype=torch.bfloat16) * 0.05)(E, De) * 0.3).to(float)), 'cg': _w(cg), 'w_r': _w(((lambda *s: torch.randn(*s, dtype=torch.bfloat16) * 0.05)(De, C) * (1.0 / float(De) ** 0.5)).to(float)), 'w_out': _w(((lambda *s: torch.randn(*s, dtype=torch.bfloat16) * 0.05)(C, C) * (1.0 / float(C) ** 0.5)).to(float))}

def reference(x, src, dst, sh, edge_attr, cg, w_r, w_out):
    N = x.shape[0]
    M = x.shape[1]
    C = x.shape[2]
    h = x[src]
    tp = torch.einsum('uvw,euc,ev->ewc', cg, h, sh)
    rw = edge_attr @ w_r
    msg = tp * rw[:, None, :]
    msg2 = msg.reshape(-1, M * C)
    agg = _segment_sum(msg2, dst, N).reshape(N, M, C)
    out = torch.einsum('nmc,cd->nmd', agg, w_out)
    return out
```

```asm
; @launch grid=(250,1,1) block=(512,1,1) lds=161600
.amdgcn_target "amdgcn-amd-amdhsa--gfx950"
.text
.globl gather_scatter__tensor_product_equiv_mace__graph_kernel
.p2align 8
.type gather_scatter__tensor_product_equiv_mace__graph_kernel,@function
gather_scatter__tensor_product_equiv_mace__graph_kernel:
s_cmp_ge_u32 s2, 250
s_cbranch_scc1 L_main_end
s_load_dwordx16 s[32:47], s[0:1], 0
s_load_dwordx4 s[48:51], s[0:1], 64
s_load_dwordx2 s[60:61], s[0:1], 80
s_memrealtime s[62:63]
v_lshrrev_b32 v11, 6, v0
v_and_b32 v1, 63, v0
v_readfirstlane_b32 s3, v11
s_cmp_lg_u32 s3, 2
s_cbranch_scc1 L_nocpf
s_getpc_b64 s[4:5]
L_pc:
v_lshlrev_b32 v12, 7, v1
v_mov_b32 v13, s5
v_add_co_u32 v12, vcc, s4, v12
s_nop 1
v_addc_co_u32 v13, vcc, 0, v13, vcc
global_load_dword v236, v[12:13], off
v_add_co_u32 v12, vcc, 0x2000, v12
s_nop 1
v_addc_co_u32 v13, vcc, 0, v13, vcc
v_cmp_gt_u32 vcc, (L_main_end-L_pc-0x2000)/128, v1
s_mov_b64 exec, vcc
global_load_dword v237, v[12:13], off
s_mov_b64 exec, -1
L_nocpf:
v_lshlrev_b32 v212, 4, v1
v_mov_b64 v[128:129], 0
v_mov_b32 v9, 128768
ds_write_b32 v9, v128
ds_write_b64 v9, v[128:129] offset:8
v_lshlrev_b32 v12, 2, v0
v_add_u32 v12, 65536, v12
ds_write_b32 v12, v128
s_lshl_b32 s52, s3, 13
s_mul_i32 s72, s2, 2560
v_lshlrev_b32 v156, 2, v0
s_lshl_b32 s80, s3, 6
s_add_u32 s80, s80, 2048
v_lshl_add_u32 v157, v1, 2, s80
v_mov_b32 v10, 1
s_waitcnt lgkmcnt(0)
s_mov_b32 s20, s50
s_mov_b32 s21, s51
s_mov_b32 s22, 256
s_mov_b32 s23, 0x20000
s_or_b32 s80, s2, s3
s_cbranch_scc1 L_nopub
s_lshl_b32 s62, s62, 3
s_or_b32 s62, s62, 0x80000000
v_mov_b32 v12, s62
v_mov_b32 v13, 0
s_mov_b64 exec, 1
buffer_store_dword v12, v13, s[20:23], 0 offen sc1
s_mov_b64 exec, -1
L_nopub:
s_mov_b32 s28, s36
s_mov_b32 s29, s37
s_mov_b32 s30, 640000
s_mov_b32 s31, 0x20000
buffer_load_dword v140, v156, s[28:31], s72 offen
s_mov_b64 exec, 0xffff
buffer_load_dword v141, v157, s[28:31], s72 offen
s_mov_b32 s24, s34
s_mov_b32 s25, s35
s_mov_b32 s26, 640000
s_mov_b32 s27, 0x20000
s_mov_b32 s16, s38
s_mov_b32 s17, s39
s_mov_b32 s18, 1280000
s_mov_b32 s19, 0x20000
buffer_load_dword v145, v157, s[24:27], s72 offen
v_lshlrev_b32 v13, 1, v157
s_lshl_b32 s73, s72, 1
buffer_load_dwordx2 v[132:133], v13, s[16:19], s73 offen
s_mov_b64 exec, -1
buffer_load_dword v144, v156, s[24:27], s72 offen
v_lshlrev_b32 v13, 1, v156
buffer_load_dwordx2 v[128:129], v13, s[16:19], s73 offen
s_cmp_lg_u32 s3, 0
s_cbranch_scc1 L_py
v_mov_b32 v12, 0
buffer_load_dword v238, v12, s[20:23], 0 offen sc1
L_py:
s_mov_b32 s8, s32
s_mov_b32 s9, s33
s_mov_b32 s10, 10240000
s_mov_b32 s11, 0x20000
s_lshr_b32 s80, s2, 3
s_sub_u32 s81, s3, 7
s_mul_i32 s81, s81, 31
s_add_u32 s80, s80, s81
s_lshl_b32 s80, s80, 13
s_cmp_lt_u32 s3, 7
s_cselect_b32 s80, 10240000, s80
v_lshlrev_b32 v12, 7, v1
buffer_load_dword v228, v12, s[8:11], s80 offen
v_lshl_or_b32 v130, v0, 1, 1
v_lshrrev_b32 v134, 1, v157
v_or_b32 v134, 1, v134
s_movk_i32 s74, 40
s_mov_b32 s75, 65536
v_lshlrev_b32 v14, 4, v0
v_and_b32 v8, 3, v0
v_and_b32 v15, 0x1fc, v0
v_add_u32 v15, s75, v15
s_barrier
s_waitcnt vmcnt(5)
v_mul_u32_u24 v12, 52429, v140
v_lshrrev_b32 v12, 21, v12
v_and_b32 v13, 7, v12
v_lshrrev_b32 v148, 3, v12
v_lshl_or_b32 v148, v13, 5, v148
v_lshl_add_u32 v13, v148, 2, s75
ds_add_rtn_u32 v152, v13, v10
v_mul_u32_u24 v12, s74, v12
v_sub_u32 v12, v140, v12
v_lshl_or_b32 v130, v12, 12, v130
v_lshlrev_b32 v148, 6, v148
s_mov_b64 exec, 0xffff
v_mul_u32_u24 v12, 52429, v141
v_lshrrev_b32 v12, 21, v12
v_and_b32 v13, 7, v12
v_lshrrev_b32 v149, 3, v12
v_lshl_or_b32 v149, v13, 5, v149
v_lshl_add_u32 v13, v149, 2, s75
ds_add_rtn_u32 v153, v13, v10
v_mul_u32_u24 v12, s74, v12
v_sub_u32 v12, v141, v12
v_lshl_or_b32 v134, v12, 12, v134
v_lshlrev_b32 v149, 6, v149
s_mov_b64 exec, -1
s_waitcnt vmcnt(1)
s_cmp_lg_u32 s3, 0
s_cbranch_scc1 L_nre
v_readfirstlane_b32 s6, v238
v_mov_b32 v12, 0
s_cmp_lg_u32 s6, 0
s_cbranch_scc1 L_nre
buffer_load_dword v238, v12, s[20:23], 0 offen sc1
L_nre:
v_lshl_or_b32 v130, v144, 18, v130
v_lshl_or_b32 v134, v145, 18, v134
s_waitcnt lgkmcnt(0)
v_lshrrev_b32 v12, 2, v152
v_and_b32 v13, 3, v152
v_lshl_add_u32 v148, v12, 14, v148
v_cmp_gt_u32 vcc, 16, v152
v_lshl_add_u32 v148, v13, 4, v148
s_mov_b64 exec, vcc
ds_write_b96 v148, v[128:130]
s_mov_b64 exec, -1
v_lshrrev_b32 v12, 2, v153
v_and_b32 v13, 3, v153
v_lshl_add_u32 v149, v12, 14, v149
v_cmp_gt_u32 vcc, 16, v153
v_lshl_add_u32 v149, v13, 4, v149
s_and_b64 exec, vcc, 0xffff
ds_write_b96 v149, v[132:134]
s_mov_b64 exec, -1
s_cmp_lg_u32 s3, 0
s_cbranch_scc1 L_non_done
s_cmp_lg_u32 s6, 0
s_cbranch_scc1 L_non_okp
s_movk_i32 s53, 4000
v_mov_b32 v12, 0
L_nonp:
s_waitcnt vmcnt(0)
v_readfirstlane_b32 s6, v238
s_cmp_lg_u32 s6, 0
s_cbranch_scc1 L_non_okp
s_sub_u32 s53, s53, 1
s_cbranch_scc1 L_non_okp
buffer_load_dword v238, v12, s[20:23], 0 offen sc1
s_branch L_nonp
L_non_okp:
ds_write_b32 v9, v238 offset:4
L_non_done:
s_mov_b32 s12, s46
s_mov_b32 s13, s47
s_mov_b32 s14, 32768
s_mov_b32 s15, 0x20000
s_lshl_b32 s80, s3, 12
s_add_u32 m0, s80, 128832
s_nop 0
buffer_load_dwordx4 v212, s[12:15], s80 offen offset:0 lds
buffer_load_dwordx4 v212, s[12:15], s80 offen offset:1024 lds
buffer_load_dwordx4 v212, s[12:15], s80 offen offset:2048 lds
buffer_load_dwordx4 v212, s[12:15], s80 offen offset:3072 lds
s_mov_b32 s20, s60
s_mov_b32 s21, s61
s_mov_b32 s22, 16512000
s_mov_b32 s23, 0x20000
s_mul_i32 s72, s2, 16512
s_add_u32 s73, s72, 8192
s_waitcnt lgkmcnt(0)
s_barrier
ds_read_b32 v13, v9 offset:4
ds_read_b32 v64, v15 offset:0
ds_read_b96 v[68:70], v14 offset:0
ds_read_b32 v65, v15 offset:512
ds_read_b96 v[72:74], v14 offset:8192
ds_read_b96 v[76:78], v14 offset:16384
ds_read_b96 v[80:82], v14 offset:24576
s_waitcnt lgkmcnt(6)
v_readfirstlane_b32 s6, v13
s_cmp_eq_u32 s6, 0
s_cbranch_scc1 L_nostore
s_waitcnt lgkmcnt(4)
v_cmp_lt_u32 vcc, v8, v64
v_max_u32 v13, 1, v64
v_add_u32 v13, -1, v13
v_cndmask_b32 v70, 0, v70, vcc
v_lshrrev_b32 v13, 2, v13
v_min_u32 v13, 4, v13
v_or_b32 v71, s6, v13
buffer_store_dwordx4 v[68:71], v14, s[20:23], s72 offen sc1
s_waitcnt lgkmcnt(2)
v_cmp_lt_u32 vcc, v8, v65
v_max_u32 v13, 1, v65
v_add_u32 v13, -1, v13
v_cndmask_b32 v74, 0, v74, vcc
v_lshrrev_b32 v13, 2, v13
v_min_u32 v13, 4, v13
v_or_b32 v75, s6, v13
buffer_store_dwordx4 v[72:75], v14, s[20:23], s73 offen sc1
v_add_u32 v8, 4, v8
s_add_u32 s72, s72, 4128000
s_add_u32 s73, s73, 4128000
s_waitcnt lgkmcnt(0)
v_cmp_lt_u32 vcc, 4, v64
v_cmp_lt_u32 s[64:65], v8, v64
v_mov_b32 v79, s6
s_mov_b64 exec, vcc
s_cbranch_execz L_n10
v_cndmask_b32 v78, 0, v78, s[64:65]
buffer_store_dwordx4 v[76:79], v14, s[20:23], s72 offen sc1
L_n10:
s_mov_b64 exec, -1
v_cmp_lt_u32 vcc, 4, v65
v_cmp_lt_u32 s[64:65], v8, v65
v_mov_b32 v83, s6
s_mov_b64 exec, vcc
s_cbranch_execz L_n11
v_cndmask_b32 v82, 0, v82, s[64:65]
buffer_store_dwordx4 v[80:83], v14, s[20:23], s73 offen sc1
L_n11:
s_mov_b64 exec, -1
v_max_u32 v13, v64, v65
v_cmp_lt_u32 vcc, 8, v13
s_cmp_eq_u64 vcc, 0
s_cbranch_scc1 L_nostore
ds_read_b96 v[164:166], v14 offset:32768
ds_read_b96 v[168:170], v14 offset:40960
ds_read_b96 v[172:174], v14 offset:49152
ds_read_b96 v[176:178], v14 offset:57344
v_add_u32 v8, 4, v8
s_add_u32 s72, s72, 4128000
s_add_u32 s73, s73, 4128000
s_waitcnt lgkmcnt(0)
v_cmp_lt_u32 vcc, 8, v64
v_cmp_lt_u32 s[64:65], v8, v64
v_mov_b32 v167, s6
s_mov_b64 exec, vcc
s_cbranch_execz L_n20
v_cndmask_b32 v166, 0, v166, s[64:65]
buffer_store_dwordx4 v[164:167], v14, s[20:23], s72 offen sc1
L_n20:
s_mov_b64 exec, -1
v_cmp_lt_u32 vcc, 8, v65
v_cmp_lt_u32 s[64:65], v8, v65
v_mov_b32 v171, s6
s_mov_b64 exec, vcc
s_cbranch_execz L_n21
v_cndmask_b32 v170, 0, v170, s[64:65]
buffer_store_dwordx4 v[168:171], v14, s[20:23], s73 offen sc1
L_n21:
s_mov_b64 exec, -1
v_add_u32 v8, 4, v8
s_add_u32 s72, s72, 4128000
s_add_u32 s73, s73, 4128000
s_waitcnt lgkmcnt(0)
v_cmp_lt_u32 vcc, 12, v64
v_cmp_lt_u32 s[64:65], v8, v64
v_mov_b32 v175, s6
s_mov_b64 exec, vcc
s_cbranch_execz L_n30
v_cndmask_b32 v174, 0, v174, s[64:65]
buffer_store_dwordx4 v[172:175], v14, s[20:23], s72 offen sc1
L_n30:
s_mov_b64 exec, -1
v_cmp_lt_u32 vcc, 12, v65
v_cmp_lt_u32 s[64:65], v8, v65
v_mov_b32 v179, s6
s_mov_b64 exec, vcc
s_cbranch_execz L_n31
v_cndmask_b32 v178, 0, v178, s[64:65]
buffer_store_dwordx4 v[176:179], v14, s[20:23], s73 offen sc1
L_n31:
s_mov_b64 exec, -1
L_nostore:
s_waitcnt lgkmcnt(0)
s_barrier
s_add_u32 m0, s52, 7168
s_cmp_ge_u32 s3, 4
s_cbranch_scc1 L_wr
s_cmp_lg_u32 s3, 0
s_cbranch_scc1 L_cg
s_mov_b32 s28, s42
s_mov_b32 s29, s43
s_mov_b32 s30, 128
s_mov_b32 s31, 0x20000
v_lshlrev_b32 v12, 2, v1
buffer_load_dword v12, s[28:31], 0 offen lds
s_branch L_cg
L_wr:
s_mov_b32 s28, s44
s_mov_b32 s29, s45
s_mov_b32 s30, 4096
s_mov_b32 s31, 0x20000
s_and_b32 s80, s3, 3
s_lshl_b32 s80, s80, 10
buffer_load_dwordx4 v212, s[28:31], s80 offen lds
L_cg:
s_mov_b32 s12, s40
s_mov_b32 s13, s41
s_mov_b32 s14, 5120000
s_mov_b32 s15, 0x20000
v_lshrrev_b32 v12, 2, v1
s_lshl_b32 s80, s3, 5
v_add_u32 v12, s80, v12
v_and_b32 v13, 3, v1
v_lshlrev_b32 v13, 4, v13
s_movk_i32 s80, 16512
v_mad_u32_u24 v90, v12, s80, v13
v_mul_u32_u24 v88, 640, v12
v_cmp_gt_u32 vcc, 234, v12
v_bfrev_b32 v15, 2
v_add_u32 v91, 264192, v90
v_add_u32 v89, 10240, v88
v_cndmask_b32 v91, v15, v91, vcc
s_mov_b64 s[94:95], vcc
s_and_b32 s7, s2, 7
s_lshl_b32 s7, s7, 5
s_lshr_b32 s81, s2, 3
s_or_b32 s7, s7, s81
s_lshl_b32 s7, s7, 6
s_add_u32 s98, s7, 4128000
s_add_u32 s99, s7, 8256000
v_mov_b64 v[128:129], 0
v_mov_b64 v[130:131], 0
v_min_u32 v134, 399, v0
v_lshlrev_b32 v134, 4, v134
v_add_u32 v134, 121856, v134
ds_write_b128 v134, v[128:131]
v_lshlrev_b32 v133, 2, v1
v_add_u32 v135, 128256, v133
ds_write_b32 v135, v1
v_mov_b32 v132, 16777215
v_add_u32 v133, s52, v133
ds_write_b32 v133, v132 offset:0
ds_write_b32 v133, v132 offset:256
ds_write_b32 v133, v132 offset:512
v_mov_b32 v136, 10240040
v_mov_b32 v137, 0
v_mov_b64 v[138:139], v[136:137]
v_lshlrev_b32 v135, 4, v0
v_add_u32 v135, 111616, v135
ds_write_b128 v135, v[136:139]
ds_write_b128 v135, v[136:139] offset:2048
v_mov_b32 v11, 64
s_mul_i32 s59, s3, 144
s_mov_b32 s100, 121856
s_mul_i32 s96, s3, 4608
s_add_u32 s96, s96, 65536
s_mul_i32 s97, s3, 1152
s_add_u32 s97, s97, 102400
v_and_b32 v92, 1, v1
v_lshlrev_b32 v92, 4, v92
v_lshrrev_b32 v94, 1, v1
v_lshl_add_u32 v94, v94, 2, s52
s_mov_b32 s24, s48
s_mov_b32 s25, s49
s_mov_b32 s26, 10240000
s_mov_b32 s27, 0x20000
s_mov_b32 s8, s32
s_mov_b32 s9, s33
s_mov_b32 s10, 10240000
s_mov_b32 s11, 0x20000
s_add_u32 s86, s52, 0
s_add_u32 s87, s52, 1024
s_add_u32 s88, s52, 2048
s_add_u32 s89, s52, 3072
s_add_u32 s90, s52, 4096
s_add_u32 s91, s52, 5120
s_add_u32 s92, s52, 6144
s_add_u32 s93, s52, 7168
s_mov_b32 s101, 102400
s_mov_b32 s82, 0x0f0f0f0f
s_mov_b32 s83, 0x0f0f0f0f
s_mov_b32 s84, 0xf0f0f0f0
s_mov_b32 s85, 0xf0f0f0f0
s_mov_b32 s56, 0
s_mov_b32 s55, 0
v_bfe_u32 v8, v1, 3, 2
v_lshrrev_b32 v14, 5, v1
v_and_b32 v12, 7, v1
v_bfe_u32 v13, v1, 4, 1
v_lshlrev_b32 v13, 2, v13
v_xor_b32 v12, v12, v13
v_lshlrev_b32 v2, 8, v8
v_lshl_add_u32 v2, v14, 7, v2
v_lshl_add_u32 v2, v12, 4, v2
v_bfe_u32 v8, v1, 2, 2
v_lshrrev_b32 v12, 4, v1
v_and_b32 v13, 2, v8
v_xor_b32 v12, v12, v13
v_lshl_add_u32 v3, v8, 7, s52
v_lshl_add_u32 v3, v12, 5, v3
v_and_b32 v13, 3, v1
v_lshl_add_u32 v3, v13, 3, v3
v_lshlrev_b32 v7, 4, v14
v_add_u32 v7, 65536, v7
s_mul_i32 s80, s3, 1280
s_add_u32 s80, s80, 111616
v_lshl_add_u32 v4, v1, 3, s80
s_add_u32 s80, s80, 4
v_lshrrev_b32 v6, 2, v1
v_lshl_add_u32 v6, v6, 3, s80
v_bfe_u32 v12, v1, 3, 2
v_and_b32 v13, 3, v1
v_lshl_add_u32 v12, v12, 2, v13
v_lshl_add_u32 v5, v12, 3, s80
v_mov_b64 v[16:17], 0
v_mov_b64 v[18:19], 0
v_mov_b64 v[20:21], 0
v_mov_b64 v[22:23], 0
v_mov_b64 v[24:25], 0
v_mov_b64 v[26:27], 0
v_mov_b64 v[28:29], 0
v_mov_b64 v[30:31], 0
v_mov_b64 v[32:33], 0
v_mov_b64 v[34:35], 0
v_mov_b64 v[36:37], 0
v_mov_b64 v[38:39], 0
v_mov_b64 v[40:41], 0
v_mov_b64 v[42:43], 0
v_mov_b64 v[44:45], 0
v_mov_b64 v[46:47], 0
v_mov_b64 v[48:49], 0
v_mov_b64 v[50:51], 0
v_mov_b64 v[52:53], 0
v_mov_b64 v[54:55], 0
v_mov_b64 v[56:57], 0
v_mov_b64 v[58:59], 0
v_mov_b64 v[60:61], 0
v_mov_b64 v[62:63], 0
v_mov_b64 v[112:113], 0
v_mov_b64 v[114:115], 0
v_mov_b64 v[116:117], 0
v_mov_b64 v[118:119], 0
buffer_load_dwordx4 v[180:183], v90, s[20:23], s7 offen sc1
buffer_load_dwordx4 v[184:187], v91, s[20:23], s7 offen sc1
s_waitcnt lgkmcnt(0)
s_barrier
s_movk_i32 s53, 4000
s_cmp_eq_u32 s6, 0
s_cbranch_scc1 L_ent_to
L_ent_chk:
s_waitcnt vmcnt(0)
L_ent_chk1:
v_xor_b32 v158, s6, v183
v_xor_b32 v159, s6, v187
v_cmp_lt_u32 s[40:41], 7, v158
v_cmp_lt_u32 s[42:43], 7, v159
s_and_b64 s[42:43], s[42:43], s[94:95]
s_or_b64 vcc, s[40:41], s[42:43]
s_cbranch_scc0 L_ent_ok
s_sub_u32 s53, s53, 1
s_cbranch_scc1 L_ent_to
s_wqm_b64 exec, s[40:41]
s_cbranch_execz L_er0
buffer_load_dwordx4 v[180:183], v90, s[20:23], s7 offen sc1
L_er0:
s_wqm_b64 exec, s[42:43]
s_cbranch_execz L_er1
buffer_load_dwordx4 v[184:187], v91, s[20:23], s7 offen sc1
L_er1:
s_mov_b64 exec, -1
s_branch L_ent_chk
L_ent_to:
s_waitcnt vmcnt(0)
ds_write_b32 v9, v10
v_mov_b32 v182, 0
v_mov_b32 v186, 0
v_mov_b64 v[158:159], 0
L_ent_ok:
v_cndmask_b32 v159, 0, v159, s[94:95]
s_mov_b32 s57, 0
s_mov_b32 s58, 0
v_cmp_ne_u32 s[40:41], 0, v158
v_cmp_ne_u32 s[42:43], 0, v159
s_mov_b64 exec, s[40:41]
s_cbranch_execz L_e10
buffer_load_dwordx4 v[188:191], v90, s[20:23], s98 offen sc1
s_mov_b32 s58, 1
v_cmp_lt_u32 vcc, 1, v158
s_mov_b64 exec, vcc
s_cbranch_execz L_e10
buffer_load_dwordx4 v[196:199], v90, s[20:23], s99 offen sc1
L_e10:
s_mov_b64 exec, s[42:43]
s_cbranch_execz L_e11
buffer_load_dwordx4 v[192:195], v91, s[20:23], s98 offen sc1
s_mov_b32 s58, 1
v_cmp_lt_u32 vcc, 1, v159
s_mov_b64 exec, vcc
s_cbranch_execz L_e11
buffer_load_dwordx4 v[200:203], v91, s[20:23], s99 offen sc1
L_e11:
s_mov_b64 exec, -1
v_and_b32 v128, 1, v182
v_cmp_ne_u32 s[64:65], 0, v128
v_bfe_u32 v130, v182, 1, 10
v_add_u32 v130, v130, v88
v_and_b32 v128, 1, v186
v_cmp_ne_u32 s[66:67], 0, v128
v_bfe_u32 v131, v186, 1, 10
v_add_u32 v131, v131, v89
v_mov_b32 v80, s57
v_mbcnt_lo_u32_b32 v80, s64, v80
v_mbcnt_hi_u32_b32 v80, s65, v80
s_bcnt1_i32_b64 s80, s[64:65]
s_add_u32 s57, s57, s80
v_lshl_add_u32 v132, v80, 2, s52
v_min_u32 v80, 143, v80
v_lshl_add_u32 v134, v80, 3, s97
v_mov_b32 v81, s57
v_mbcnt_lo_u32_b32 v81, s66, v81
v_mbcnt_hi_u32_b32 v81, s67, v81
s_bcnt1_i32_b64 s80, s[66:67]
s_add_u32 s57, s57, s80
v_lshl_add_u32 v133, v81, 2, s52
v_min_u32 v81, 143, v81
v_lshl_add_u32 v135, v81, 3, s97
s_mov_b64 exec, s[64:65]
ds_write_b32 v132, v130
ds_write_b64 v134, v[180:181]
s_mov_b64 exec, s[66:67]
ds_write_b32 v133, v131
ds_write_b64 v135, v[184:185]
s_mov_b64 exec, -1
ds_read_b32 v144, v94 offset:0
v_bfe_u32 v136, v182, 12, 6
v_lshrrev_b32 v64, 26, v182
v_mad_u32_u24 v64, v136, 40, v64
v_lshl_add_u32 v64, v64, 2, s100
v_lshl_add_u32 v136, v136, 2, s100
v_add_u32 v80, s59, v80
v_bfe_u32 v137, v186, 12, 6
v_lshrrev_b32 v65, 26, v186
v_mad_u32_u24 v65, v137, 40, v65
v_lshl_add_u32 v65, v65, 2, s100
v_lshl_add_u32 v137, v137, 2, s100
v_add_u32 v81, s59, v81
s_mov_b64 exec, s[64:65]
ds_add_u32 v136, v11 offset:6400
ds_add_rtn_u32 v72, v64, v10
s_mov_b64 exec, s[66:67]
ds_add_u32 v137, v11 offset:6400
ds_add_rtn_u32 v73, v65, v10
s_mov_b64 exec, -1
s_waitcnt lgkmcnt(4)
s_add_u32 m0, s96, 0
v_lshl_add_u32 v154, v144, 5, v92
buffer_load_dwordx4 v154, s[12:15], 0 offen lds
s_cmp_eq_u32 s58, 0
s_cbranch_scc1 L_noext
s_max_u32 s57, s57, 32
s_waitcnt vmcnt(1)
s_movk_i32 s53, 4000
s_branch L_x1_chk
L_x1_again:
s_mov_b64 exec, s[40:41]
s_cbranch_execz L_x1_s0
buffer_load_dwordx4 v[188:191], v90, s[20:23], s98 offen sc1
L_x1_s0:
s_mov_b64 exec, s[42:43]
s_cbranch_execz L_x1_s1
buffer_load_dwordx4 v[192:195], v91, s[20:23], s98 offen sc1
L_x1_s1:
s_mov_b64 exec, -1
s_waitcnt vmcnt(0)
L_x1_chk:
v_cmp_ne_u32 vcc, s6, v191
v_cmp_ne_u32 s[44:45], s6, v195
s_and_b64 vcc, vcc, s[40:41]
s_and_b64 s[44:45], s[44:45], s[42:43]
s_or_b64 vcc, vcc, s[44:45]
s_cbranch_scc0 L_x1_ok
s_sub_u32 s53, s53, 1
s_cbranch_scc0 L_x1_again
ds_write_b32 v9, v10
s_mov_b64 s[40:41], 0
s_mov_b64 s[42:43], 0
L_x1_ok:
v_cndmask_b32 v190, 0, v190, s[40:41]
v_cndmask_b32 v194, 0, v194, s[42:43]
v_and_b32 v128, 1, v190
v_cmp_ne_u32 s[68:69], 0, v128
v_bfe_u32 v130, v190, 1, 10
v_add_u32 v130, v130, v88
v_and_b32 v128, 1, v194
v_cmp_ne_u32 s[70:71], 0, v128
v_bfe_u32 v131, v194, 1, 10
v_add_u32 v131, v131, v89
v_mov_b32 v82, s57
v_mbcnt_lo_u32_b32 v82, s68, v82
v_mbcnt_hi_u32_b32 v82, s69, v82
s_bcnt1_i32_b64 s80, s[68:69]
s_add_u32 s57, s57, s80
v_lshl_add_u32 v132, v82, 2, s52
v_min_u32 v82, 143, v82
v_lshl_add_u32 v134, v82, 3, s97
v_mov_b32 v83, s57
v_mbcnt_lo_u32_b32 v83, s70, v83
v_mbcnt_hi_u32_b32 v83, s71, v83
s_bcnt1_i32_b64 s80, s[70:71]
s_add_u32 s57, s57, s80
v_lshl_add_u32 v133, v83, 2, s52
v_min_u32 v83, 143, v83
v_lshl_add_u32 v135, v83, 3, s97
s_mov_b64 exec, s[68:69]
ds_write_b32 v132, v130
ds_write_b64 v134, v[188:189]
s_mov_b64 exec, s[70:71]
ds_write_b32 v133, v131
ds_write_b64 v135, v[192:193]
s_mov_b64 exec, -1
v_bfe_u32 v136, v190, 12, 6
v_lshrrev_b32 v66, 26, v190
v_mad_u32_u24 v66, v136, 40, v66
v_lshl_add_u32 v66, v66, 2, s100
v_lshl_add_u32 v136, v136, 2, s100
v_add_u32 v82, s59, v82
v_bfe_u32 v137, v194, 12, 6
v_lshrrev_b32 v67, 26, v194
v_mad_u32_u24 v67, v137, 40, v67
v_lshl_add_u32 v67, v67, 2, s100
v_lshl_add_u32 v137, v137, 2, s100
v_add_u32 v83, s59, v83
s_mov_b64 exec, s[68:69]
ds_add_u32 v136, v11 offset:6400
ds_add_rtn_u32 v74, v66, v10
s_mov_b64 exec, s[70:71]
ds_add_u32 v137, v11 offset:6400
ds_add_rtn_u32 v75, v67, v10
s_mov_b64 exec, -1
v_cmp_lt_u32 s[40:41], 1, v158
v_cmp_lt_u32 s[42:43], 1, v159
s_or_b64 vcc, s[40:41], s[42:43]
s_cbranch_scc0 L_noext
s_mov_b32 s58, 2
s_movk_i32 s53, 4000
s_branch L_x2_chk
L_x2_again:
s_mov_b64 exec, s[40:41]
s_cbranch_execz L_x2_s0
buffer_load_dwordx4 v[196:199], v90, s[20:23], s99 offen sc1
L_x2_s0:
s_mov_b64 exec, s[42:43]
s_cbranch_execz L_x2_s1
buffer_load_dwordx4 v[200:203], v91, s[20:23], s99 offen sc1
L_x2_s1:
s_mov_b64 exec, -1
s_waitcnt vmcnt(0)
L_x2_chk:
v_cmp_ne_u32 vcc, s6, v199
v_cmp_ne_u32 s[44:45], s6, v203
s_and_b64 vcc, vcc, s[40:41]
s_and_b64 s[44:45], s[44:45], s[42:43]
s_or_b64 vcc, vcc, s[44:45]
s_cbranch_scc0 L_x2_ok
s_sub_u32 s53, s53, 1
s_cbranch_scc0 L_x2_again
ds_write_b32 v9, v10
s_mov_b64 s[40:41], 0
s_mov_b64 s[42:43], 0
L_x2_ok:
v_cndmask_b32 v198, 0, v198, s[40:41]
v_cndmask_b32 v202, 0, v202, s[42:43]
v_and_b32 v128, 1, v198
v_cmp_ne_u32 s[72:73], 0, v128
v_bfe_u32 v130, v198, 1, 10
v_add_u32 v130, v130, v88
v_and_b32 v128, 1, v202
v_cmp_ne_u32 s[74:75], 0, v128
v_bfe_u32 v131, v202, 1, 10
v_add_u32 v131, v131, v89
v_mov_b32 v84, s57
v_mbcnt_lo_u32_b32 v84, s72, v84
v_mbcnt_hi_u32_b32 v84, s73, v84
s_bcnt1_i32_b64 s80, s[72:73]
s_add_u32 s57, s57, s80
v_lshl_add_u32 v132, v84, 2, s52
v_min_u32 v84, 143, v84
v_lshl_add_u32 v134, v84, 3, s97
v_mov_b32 v85, s57
v_mbcnt_lo_u32_b32 v85, s74, v85
v_mbcnt_hi_u32_b32 v85, s75, v85
s_bcnt1_i32_b64 s80, s[74:75]
s_add_u32 s57, s57, s80
v_lshl_add_u32 v133, v85, 2, s52
v_min_u32 v85, 143, v85
v_lshl_add_u32 v135, v85, 3, s97
s_mov_b64 exec, s[72:73]
ds_write_b32 v132, v130
ds_write_b64 v134, v[196:197]
s_mov_b64 exec, s[74:75]
ds_write_b32 v133, v131
ds_write_b64 v135, v[200:201]
s_mov_b64 exec, -1
v_bfe_u32 v136, v198, 12, 6
v_lshrrev_b32 v68, 26, v198
v_mad_u32_u24 v68, v136, 40, v68
v_lshl_add_u32 v68, v68, 2, s100
v_lshl_add_u32 v136, v136, 2, s100
v_add_u32 v84, s59, v84
v_bfe_u32 v137, v202, 12, 6
v_lshrrev_b32 v69, 26, v202
v_mad_u32_u24 v69, v137, 40, v69
v_lshl_add_u32 v69, v69, 2, s100
v_lshl_add_u32 v137, v137, 2, s100
v_add_u32 v85, s59, v85
s_mov_b64 exec, s[72:73]
ds_add_u32 v136, v11 offset:6400
ds_add_rtn_u32 v76, v68, v10
s_mov_b64 exec, s[74:75]
ds_add_u32 v137, v11 offset:6400
ds_add_rtn_u32 v77, v69, v10
s_mov_b64 exec, -1
v_cmp_lt_u32 s[40:41], 2, v158
v_cmp_lt_u32 s[42:43], 2, v159
s_or_b64 vcc, s[40:41], s[42:43]
s_cbranch_scc0 L_noext
s_mov_b32 s58, 3
s_add_u32 s99, s99, 4128000
v_mov_b32 v207, 0
v_mov_b32 v211, 0
s_movk_i32 s53, 4000
s_branch L_x3_chk
L_x3_again:
s_mov_b64 exec, s[40:41]
s_cbranch_execz L_x3_s0
buffer_load_dwordx4 v[204:207], v90, s[20:23], s99 offen sc1
L_x3_s0:
s_mov_b64 exec, s[42:43]
s_cbranch_execz L_x3_s1
buffer_load_dwordx4 v[208:211], v91, s[20:23], s99 offen sc1
L_x3_s1:
s_mov_b64 exec, -1
s_waitcnt vmcnt(0)
L_x3_chk:
v_cmp_ne_u32 vcc, s6, v207
v_cmp_ne_u32 s[44:45], s6, v211
s_and_b64 vcc, vcc, s[40:41]
s_and_b64 s[44:45], s[44:45], s[42:43]
s_or_b64 vcc, vcc, s[44:45]
s_cbranch_scc0 L_x3_ok
s_sub_u32 s53, s53, 1
s_cbranch_scc0 L_x3_again
ds_write_b32 v9, v10
s_mov_b64 s[40:41], 0
s_mov_b64 s[42:43], 0
L_x3_ok:
v_cndmask_b32 v206, 0, v206, s[40:41]
v_cndmask_b32 v210, 0, v210, s[42:43]
v_and_b32 v128, 1, v206
v_cmp_ne_u32 s[76:77], 0, v128
v_bfe_u32 v130, v206, 1, 10
v_add_u32 v130, v130, v88
v_and_b32 v128, 1, v210
v_cmp_ne_u32 s[78:79], 0, v128
v_bfe_u32 v131, v210, 1, 10
v_add_u32 v131, v131, v89
v_mov_b32 v86, s57
v_mbcnt_lo_u32_b32 v86, s76, v86
v_mbcnt_hi_u32_b32 v86, s77, v86
s_bcnt1_i32_b64 s80, s[76:77]
s_add_u32 s57, s57, s80
v_lshl_add_u32 v132, v86, 2, s52
v_min_u32 v86, 143, v86
v_lshl_add_u32 v134, v86, 3, s97
v_mov_b32 v87, s57
v_mbcnt_lo_u32_b32 v87, s78, v87
v_mbcnt_hi_u32_b32 v87, s79, v87
s_bcnt1_i32_b64 s80, s[78:79]
s_add_u32 s57, s57, s80
v_lshl_add_u32 v133, v87, 2, s52
v_min_u32 v87, 143, v87
v_lshl_add_u32 v135, v87, 3, s97
s_mov_b64 exec, s[76:77]
ds_write_b32 v132, v130
ds_write_b64 v134, v[204:205]
s_mov_b64 exec, s[78:79]
ds_write_b32 v133, v131
ds_write_b64 v135, v[208:209]
s_mov_b64 exec, -1
v_bfe_u32 v136, v206, 12, 6
v_lshrrev_b32 v70, 26, v206
v_mad_u32_u24 v70, v136, 40, v70
v_lshl_add_u32 v70, v70, 2, s100
v_lshl_add_u32 v136, v136, 2, s100
v_add_u32 v86, s59, v86
v_bfe_u32 v137, v210, 12, 6
v_lshrrev_b32 v71, 26, v210
v_mad_u32_u24 v71, v137, 40, v71
v_lshl_add_u32 v71, v71, 2, s100
v_lshl_add_u32 v137, v137, 2, s100
v_add_u32 v87, s59, v87
s_mov_b64 exec, s[76:77]
ds_add_u32 v136, v11 offset:6400
ds_add_rtn_u32 v78, v70, v10
s_mov_b64 exec, s[78:79]
ds_add_u32 v137, v11 offset:6400
ds_add_rtn_u32 v79, v71, v10
s_mov_b64 exec, -1
v_max_u32 v128, v158, v159
v_cmp_eq_u32 vcc, 4, v128
s_mov_b64 exec, vcc
ds_write_b32 v9, v10
s_mov_b64 exec, -1
L_noext:
ds_read_b32 v145, v94 offset:128
ds_read_b32 v146, v94 offset:256
ds_read_b32 v147, v94 offset:384
ds_read_b32 v148, v94 offset:512
s_cmp_le_u32 s57, 144
s_cbranch_scc1 L_nwok
ds_write_b32 v9, v10
L_nwok:
s_waitcnt lgkmcnt(0)
s_cmp_le_u32 s57, 32
s_cbranch_scc1 L_rd_f1
s_add_u32 m0, s96, 1024
v_lshl_add_u32 v154, v145, 5, v92
buffer_load_dwordx4 v154, s[12:15], 0 offen lds
L_rd_f1:
s_waitcnt lgkmcnt(0)
s_barrier
s_or_b32 s80, s2, s3
s_cbranch_scc1 L_noreset
s_mov_b32 s28, s50
s_mov_b32 s29, s51
s_mov_b32 s30, 256
s_mov_b32 s31, 0x20000
v_mov_b32 v128, 0
s_mov_b64 exec, 1
buffer_store_dword v128, v128, s[28:31], 0 offen sc1
s_mov_b64 exec, -1
L_noreset:
v_lshlrev_b32 v128, 2, v1
v_add_u32 v128, 121856, v128
ds_read_b32 v129, v128 offset:6400
s_mul_i32 s81, s3, 5
v_add_u32 v131, s81, v1
s_mov_b32 exec_hi, 0xff
s_waitcnt lgkmcnt(0)
v_readlane_b32 s40, v129, s81
s_add_u32 s81, s81, 1
v_readlane_b32 s41, v129, s81
s_add_u32 s81, s81, 1
v_readlane_b32 s42, v129, s81
s_add_u32 s81, s81, 1
v_readlane_b32 s43, v129, s81
s_add_u32 s81, s81, 1
v_readlane_b32 s44, v129, s81
s_add_u32 s81, s81, 1
v_cmp_lt_u32 vcc, s40, v129
s_bcnt1_i32_b64 s40, vcc
v_cmp_lt_u32 vcc, s41, v129
s_bcnt1_i32_b64 s41, vcc
v_cmp_lt_u32 vcc, s42, v129
s_bcnt1_i32_b64 s42, vcc
v_cmp_lt_u32 vcc, s43, v129
s_bcnt1_i32_b64 s43, vcc
v_cmp_lt_u32 vcc, s44, v129
s_bcnt1_i32_b64 s44, vcc
v_writelane_b32 v130, s40, 0
v_writelane_b32 v130, s41, 1
v_writelane_b32 v130, s42, 2
v_writelane_b32 v130, s43, 3
v_writelane_b32 v130, s44, 4
s_mov_b64 exec, 0x1f
v_lshrrev_b32 v132, 3, v130
v_lshlrev_b32 v133, 2, v132
s_mov_b32 s40, 463648
v_lshrrev_b32 v133, v133, s40
v_xor_b32 v130, v130, v133
v_and_b32 v130, 7, v130
v_lshl_add_u32 v130, v130, 3, v132
v_lshlrev_b32 v130, 2, v130
v_add_u32 v130, 128512, v130
ds_write_b32 v130, v131
s_mov_b64 exec, -1
s_waitcnt lgkmcnt(0)
s_barrier
s_lshl_b32 s80, s3, 5
s_add_u32 s80, s80, 128512
v_mov_b32 v129, s80
ds_read_b128 v[132:135], v129
ds_read_b32 v136, v129 offset:16
s_waitcnt lgkmcnt(0)
s_movk_i32 s80, 160
v_mad_u32_u24 v132, v132, s80, v128
ds_read_b32 v138, v132
v_mad_u32_u24 v133, v133, s80, v128
ds_read_b32 v139, v133
v_mad_u32_u24 v134, v134, s80, v128
ds_read_b32 v140, v134
v_mad_u32_u24 v135, v135, s80, v128
ds_read_b32 v141, v135
v_mad_u32_u24 v136, v136, s80, v128
ds_read_b32 v142, v136
s_mul_i32 s80, s3, 160
s_add_u32 s80, s80, 13952
s_waitcnt lgkmcnt(0)
v_add3_u32 v128, v138, v139, v140
v_add3_u32 v128, v128, v141, v142
v_mov_b32 v129, v128
s_nop 1
v_add_u32_dpp v129, v129, v129 row_shr:1 row_mask:0xf bank_mask:0xf bound_ctrl:0
s_nop 1
v_add_u32_dpp v129, v129, v129 row_shr:2 row_mask:0xf bank_mask:0xf bound_ctrl:0
s_nop 1
v_add_u32_dpp v129, v129, v129 row_shr:4 row_mask:0xf bank_mask:0xf bound_ctrl:0
s_nop 1
v_add_u32_dpp v129, v129, v129 row_shr:8 row_mask:0xf bank_mask:0xf bound_ctrl:0
s_nop 1
v_add_u32_dpp v129, v129, v129 row_bcast:15 row_mask:0xa bank_mask:0xf
s_nop 1
v_add_u32_dpp v129, v129, v129 row_bcast:31 row_mask:0xc bank_mask:0xf
s_nop 0
v_readlane_b32 s54, v129, 39
v_sub_u32 v129, v129, v128
v_add_u32 v129, s80, v129
s_mov_b32 s80, 0x1000000
s_mov_b32 exec_hi, 0xff
ds_write_b32 v132, v129
v_add3_u32 v129, v129, v138, s80
ds_write_b32 v133, v129
v_add3_u32 v129, v129, v139, s80
ds_write_b32 v134, v129
v_add3_u32 v129, v129, v140, s80
ds_write_b32 v135, v129
v_add3_u32 v129, v129, v141, s80
ds_write_b32 v136, v129
s_mov_b32 exec_hi, -1
s_cmp_le_u32 s54, 128
s_cbranch_scc1 L_nof_f
ds_write_b32 v9, v10
L_nof_f:
s_waitcnt lgkmcnt(0)
s_barrier
ds_read_b32 v156, v9
ds_read_b32 v64, v64
ds_read_b32 v65, v65
v_lshrrev_b32 v128, 18, v182
v_lshlrev_b32 v128, 10, v128
v_mov_b32 v129, v80
v_lshrrev_b32 v130, 18, v186
v_lshlrev_b32 v130, 10, v130
v_mov_b32 v131, v81
s_cmp_lt_u32 s58, 1
s_cbranch_scc1 L_p3a_f
ds_read_b32 v66, v66
ds_read_b32 v67, v67
v_lshrrev_b32 v132, 18, v190
v_lshlrev_b32 v132, 10, v132
v_mov_b32 v133, v82
v_lshrrev_b32 v134, 18, v194
v_lshlrev_b32 v134, 10, v134
v_mov_b32 v135, v83
s_cmp_lt_u32 s58, 2
s_cbranch_scc1 L_p3a_f
ds_read_b32 v68, v68
ds_read_b32 v69, v69
v_lshrrev_b32 v136, 18, v198
v_lshlrev_b32 v136, 10, v136
v_mov_b32 v137, v84
v_lshrrev_b32 v138, 18, v202
v_lshlrev_b32 v138, 10, v138
v_mov_b32 v139, v85
s_cmp_lt_u32 s58, 3
s_cbranch_scc1 L_p3a_f
ds_read_b32 v70, v70
ds_read_b32 v71, v71
v_lshrrev_b32 v140, 18, v206
v_lshlrev_b32 v140, 10, v140
v_mov_b32 v141, v86
v_lshrrev_b32 v142, 18, v210
v_lshlrev_b32 v142, 10, v142
v_mov_b32 v143, v87
L_p3a_f:
s_waitcnt lgkmcnt(0)
v_readfirstlane_b32 s80, v156
s_cmp_lg_u32 s80, 0
s_cbranch_scc1 L_goslow
v_lshrrev_b32 v157, 21, v64
v_or_b32 v128, v128, v157
v_and_b32 v64, 0xffffff, v64
v_add_lshl_u32 v64, v72, v64, 3
v_lshrrev_b32 v157, 21, v65
v_or_b32 v130, v130, v157
v_and_b32 v65, 0xffffff, v65
v_add_lshl_u32 v65, v73, v65, 3
s_mov_b64 exec, s[64:65]
ds_write_b64 v64, v[128:129]
s_mov_b64 exec, s[66:67]
ds_write_b64 v65, v[130:131]
s_mov_b64 exec, -1
s_cmp_lt_u32 s58, 1
s_cbranch_scc1 L_p3b_f
v_lshrrev_b32 v157, 21, v66
v_or_b32 v132, v132, v157
v_and_b32 v66, 0xffffff, v66
v_add_lshl_u32 v66, v74, v66, 3
v_lshrrev_b32 v157, 21, v67
v_or_b32 v134, v134, v157
v_and_b32 v67, 0xffffff, v67
v_add_lshl_u32 v67, v75, v67, 3
s_mov_b64 exec, s[68:69]
ds_write_b64 v66, v[132:133]
s_mov_b64 exec, s[70:71]
ds_write_b64 v67, v[134:135]
s_mov_b64 exec, -1
s_cmp_lt_u32 s58, 2
s_cbranch_scc1 L_p3b_f
v_lshrrev_b32 v157, 21, v68
v_or_b32 v136, v136, v157
v_and_b32 v68, 0xffffff, v68
v_add_lshl_u32 v68, v76, v68, 3
v_lshrrev_b32 v157, 21, v69
v_or_b32 v138, v138, v157
v_and_b32 v69, 0xffffff, v69
v_add_lshl_u32 v69, v77, v69, 3
s_mov_b64 exec, s[72:73]
ds_write_b64 v68, v[136:137]
s_mov_b64 exec, s[74:75]
ds_write_b64 v69, v[138:139]
s_mov_b64 exec, -1
s_cmp_lt_u32 s58, 3
s_cbranch_scc1 L_p3b_f
v_lshrrev_b32 v157, 21, v70
v_or_b32 v140, v140, v157
v_and_b32 v70, 0xffffff, v70
v_add_lshl_u32 v70, v78, v70, 3
v_lshrrev_b32 v157, 21, v71
v_or_b32 v142, v142, v157
v_and_b32 v71, 0xffffff, v71
v_add_lshl_u32 v71, v79, v71, 3
s_mov_b64 exec, s[76:77]
ds_write_b64 v70, v[140:141]
s_mov_b64 exec, s[78:79]
ds_write_b64 v71, v[142:143]
s_mov_b64 exec, -1
L_p3b_f:
s_cmp_le_u32 s57, 64
s_cbranch_scc1 L_rd_f2
s_add_u32 m0, s96, 2048
v_lshl_add_u32 v154, v146, 5, v92
buffer_load_dwordx4 v154, s[12:15], 0 offen lds
L_rd_f2:
s_cmp_le_u32 s57, 96
s_cbranch_scc1 L_rd_f3
s_add_u32 m0, s96, 3072
v_lshl_add_u32 v154, v147, 5, v92
buffer_load_dwordx4 v154, s[12:15], 0 offen lds
L_rd_f3:
s_cmp_le_u32 s57, 128
s_cbranch_scc1 L_rd_f4
s_mov_b32 exec_hi, 0
s_add_u32 m0, s96, 4096
v_lshl_add_u32 v154, v148, 5, v92
buffer_load_dwordx4 v154, s[12:15], 0 offen lds
s_mov_b32 exec_hi, -1
L_rd_f4:
s_waitcnt lgkmcnt(0)
s_barrier
L_sweep:
ds_read_b32 v160, v4 offset:0
ds_read_b32 v162, v5 offset:0
ds_read_b32 v163, v6 offset:0
s_waitcnt lgkmcnt(0)
v_readlane_b32 s64, v160, 0
v_readlane_b32 s65, v160, 1
v_readlane_b32 s66, v160, 2
v_readlane_b32 s67, v160, 3
v_readlane_b32 s68, v160, 4
v_readlane_b32 s69, v160, 5
v_readlane_b32 s70, v160, 6
v_readlane_b32 s71, v160, 7
v_readlane_b32 s72, v160, 8
s_mov_b32 m0, s86
s_and_b32 s80, s64, 0xfffffc00
buffer_load_dwordx4 v2, s[8:11], s80 offen lds
s_mov_b32 m0, s87
s_and_b32 s80, s65, 0xfffffc00
buffer_load_dwordx4 v2, s[8:11], s80 offen lds
s_mov_b32 m0, s88
s_and_b32 s80, s66, 0xfffffc00
buffer_load_dwordx4 v2, s[8:11], s80 offen lds
s_mov_b32 m0, s89
s_and_b32 s80, s67, 0xfffffc00
buffer_load_dwordx4 v2, s[8:11], s80 offen lds
s_mov_b32 m0, s90
s_and_b32 s80, s68, 0xfffffc00
buffer_load_dwordx4 v2, s[8:11], s80 offen lds
s_mov_b32 m0, s91
s_and_b32 s80, s69, 0xfffffc00
buffer_load_dwordx4 v2, s[8:11], s80 offen lds
s_mov_b32 m0, s92
s_and_b32 s80, s70, 0xfffffc00
buffer_load_dwordx4 v2, s[8:11], s80 offen lds
s_cmp_lg_u32 s55, 0
s_cbranch_scc1 L_nosf
v_lshrrev_b32 v13, 5, v1
v_bfe_u32 v14, v1, 4, 1
v_lshlrev_b32 v13, 14, v13
v_lshl_add_u32 v13, v14, 5, v13
v_bfe_u32 v12, v1, 2, 2
v_lshl_add_u32 v13, v12, 8, v13
v_and_b32 v12, 3, v1
v_lshl_add_u32 v13, v12, 3, v13
v_lshlrev_b32 v14, 1, v12
ds_read_u16 v164, v14 offset:7168
ds_read_u16 v165, v14 offset:7176
ds_read_u16 v166, v14 offset:7184
ds_read_u16 v167, v14 offset:7192
ds_read_u16 v168, v14 offset:7200
ds_read_u16 v169, v14 offset:7208
ds_read_u16 v170, v14 offset:7216
ds_read_u16 v171, v14 offset:7224
ds_read_u16 v172, v14 offset:7232
ds_read_u16 v173, v14 offset:7240
ds_read_u16 v174, v14 offset:7248
ds_read_u16 v175, v14 offset:7256
s_waitcnt lgkmcnt(4)
ds_read_u16 v176, v14 offset:7264
ds_read_u16 v177, v14 offset:7272
ds_read_u16 v178, v14 offset:7280
ds_read_u16 v179, v14 offset:7288
s_waitcnt lgkmcnt(4)
ds_read_b64_tr_b16 v[96:97], v13 offset:39936
ds_read_b64_tr_b16 v[98:99], v13 offset:48128
ds_read_b64_tr_b16 v[100:101], v13 offset:40000
ds_read_b64_tr_b16 v[102:103], v13 offset:48192
ds_read_b64_tr_b16 v[104:105], v13 offset:40064
ds_read_b64_tr_b16 v[106:107], v13 offset:48256
ds_read_b64_tr_b16 v[108:109], v13 offset:40128
ds_read_b64_tr_b16 v[110:111], v13 offset:48320
s_waitcnt lgkmcnt(8)
v_lshl_or_b32 v120, v165, 16, v164
v_lshl_or_b32 v121, v167, 16, v166
v_lshl_or_b32 v122, v169, 16, v168
v_lshl_or_b32 v123, v171, 16, v170
v_lshl_or_b32 v124, v173, 16, v172
v_lshl_or_b32 v125, v175, 16, v174
v_lshl_or_b32 v126, v177, 16, v176
v_lshl_or_b32 v127, v179, 16, v178
s_waitcnt lgkmcnt(0)
s_and_b32 s81, s3, 1
s_lshl_b32 s80, s81, 3
s_bfe_u32 s81, s3, 0x10001
s_lshl_b32 s81, s81, 6
s_add_u32 s80, s80, s81
s_add_u32 s80, s80, s52
v_mul_u32_u24 v244, 48, v1
v_add_u32 v244, s80, v244
v_lshrrev_b32 v12, 4, v1
v_bfe_u32 v13, v1, 2, 2
v_and_b32 v14, 3, v1
v_lshl_add_u32 v245, v12, 3, v13
v_mul_u32_u24 v245, 48, v245
v_lshl_add_u32 v245, v14, 13, v245
v_and_b32 v15, 1, v14
v_lshl_add_u32 v245, v15, 3, v245
v_lshrrev_b32 v15, 1, v14
v_lshl_add_u32 v245, v15, 6, v245
s_lshr_b32 s80, s3, 2
s_bfe_u32 s42, s3, 0x10001
s_xor_b32 s42, s42, s80
s_lshl_b32 s43, s80, 2
s_add_u32 s43, s43, 128776
v_mov_b32 v247, s43
s_lshl_b32 s40, s80, 15
s_lshl_b32 s41, s42, 3
s_add_u32 s40, s40, s41
v_add_u32 v245, s40, v245
s_lshl_b32 s40, s80, 7
s_lshl_b32 s41, s42, 2
s_add_u32 s40, s40, s41
s_add_u32 s40, s40, 128512
v_lshl_add_u32 v248, v12, 5, s40
v_and_b32 v13, 15, v1
s_and_b32 s41, s3, 1
s_lshl_b32 s41, s41, 7
v_lshl_add_u32 v249, v13, 3, s41
v_lshl_add_u32 v246, v12, 11, v249
v_add_u32 v246, 128832, v246
s_mov_b32 s63, 0
s_mov_b32 s62, s42
s_mov_b32 s44, 0x05040100
s_mov_b32 s45, 0x07060302
L_nosf:
s_waitcnt vmcnt(7)
s_barrier
s_setprio 2
v_lshl_add_u32 v162, v162, 5, v7
v_lshl_add_u32 v163, v163, 3, s101
ds_read_b64 v[128:129], v163
s_mov_b64 exec, s[82:83]
ds_read_b128 v[112:115], v162
s_mov_b64 exec, s[84:85]
ds_read_b128 v[116:119], v162
s_mov_b64 exec, -1
s_mov_b32 m0, s93
s_and_b32 s80, s71, 0xfffffc00
buffer_load_dwordx4 v2, s[8:11], s80 offen lds
s_sub_u32 s53, s54, 1
s_cbranch_scc1 L_sweep_done
s_waitcnt vmcnt(7)
ds_read_b64_tr_b16 v[136:137], v3 offset:0
ds_read_b64_tr_b16 v[138:139], v3 offset:512
s_waitcnt lgkmcnt(2)
v_dot2_f32_bf16 v130, v128, v120, 0
v_dot2_f32_bf16 v131, v128, v122, 0
v_dot2_f32_bf16 v132, v128, v124, 0
v_dot2_f32_bf16 v133, v128, v126, 0
v_dot2_f32_bf16 v130, v129, v121, v130
v_dot2_f32_bf16 v131, v129, v123, v131
v_dot2_f32_bf16 v132, v129, v125, v132
v_dot2_f32_bf16 v133, v129, v127, v133
v_mfma_f32_32x32x16_bf16 v[64:79], v[112:115], v[96:99], 0
v_mfma_f32_32x32x16_bf16 v[64:79], v[116:119], v[100:103], v[64:79]
v_mfma_f32_32x32x16_bf16 v[80:95], v[112:115], v[104:107], 0
v_mfma_f32_32x32x16_bf16 v[80:95], v[116:119], v[108:111], v[80:95]
v_cvt_pk_bf16_f32 v134, v130, v131
v_cvt_pk_bf16_f32 v135, v132, v133
s_waitcnt vmcnt(6)
ds_read_b64_tr_b16 v[140:141], v3 offset:1024
ds_read_b64_tr_b16 v[142:143], v3 offset:1536
s_waitcnt lgkmcnt(2)
v_mfma_f32_4x4x4_16b_bf16 v[144:147], v[134:135], v[136:137], 0 cbsz:4 abid:0
v_mfma_f32_4x4x4_16b_bf16 v[148:151], v[134:135], v[138:139], 0 cbsz:4 abid:0
s_mov_b32 m0, s86
s_and_b32 s80, s72, 0xfffffc00
buffer_load_dwordx4 v2, s[8:11], s80 offen lds
L_loop:
s_waitcnt vmcnt(4)
ds_read_b64_tr_b16 v[136:137], v3 offset:2048
ds_read_b64_tr_b16 v[138:139], v3 offset:2560
v_readlane_b32 s73, v160, 9
s_waitcnt lgkmcnt(2)
v_mfma_f32_4x4x4_16b_bf16 v[152:155], v[134:135], v[140:141], 0 cbsz:4 abid:1
v_mfma_f32_4x4x4_16b_bf16 v[156:159], v[134:135], v[142:143], 0 cbsz:4 abid:1
s_mov_b32 m0, s87
s_and_b32 s80, s73, 0xfffffc00
buffer_load_dwordx4 v2, s[8:11], s80 offen lds
ds_read_b32 v161, v4 offset:128
ds_read_b32 v162, v5 offset:128
ds_read_b32 v163, v6 offset:128
v_add_u32 v4, 128, v4
v_add_u32 v5, 128, v5
v_add_u32 v6, 128, v6
s_set_gpr_idx_on s64, gpr_idx(SRC2,DST)
v_fmac_f32 v16, v144, v64
v_fmac_f32 v17, v145, v64
v_fmac_f32 v18, v146, v64
v_fmac_f32 v19, v147, v64
v_fmac_f32 v20, v148, v80
v_fmac_f32 v21, v149, v80
v_fmac_f32 v22, v150, v80
v_fmac_f32 v23, v151, v80
s_set_gpr_idx_off
s_sub_u32 s53, s53, 1
s_cbranch_scc1 L_sweep_done
s_waitcnt vmcnt(4)
ds_read_b64_tr_b16 v[140:141], v3 offset:3072
ds_read_b64_tr_b16 v[142:143], v3 offset:3584
v_readlane_b32 s74, v160, 10
s_waitcnt lgkmcnt(5)
v_mfma_f32_4x4x4_16b_bf16 v[144:147], v[134:135], v[136:137], 0 cbsz:4 abid:2
v_mfma_f32_4x4x4_16b_bf16 v[148:151], v[134:135], v[138:139], 0 cbsz:4 abid:2
s_mov_b32 m0, s88
s_and_b32 s80, s74, 0xfffffc00
buffer_load_dwordx4 v2, s[8:11], s80 offen lds
s_set_gpr_idx_on s65, gpr_idx(SRC2,DST)
v_fmac_f32 v16, v152, v65
v_fmac_f32 v17, v153, v65
v_fmac_f32 v18, v154, v65
v_fmac_f32 v19, v155, v65
v_fmac_f32 v20, v156, v81
v_fmac_f32 v21, v157, v81
v_fmac_f32 v22, v158, v81
v_fmac_f32 v23, v159, v81
s_set_gpr_idx_off
s_sub_u32 s53, s53, 1
s_cbranch_scc1 L_sweep_done
s_waitcnt vmcnt(4)
ds_read_b64_tr_b16 v[136:137], v3 offset:4096
ds_read_b64_tr_b16 v[138:139], v3 offset:4608
v_readlane_b32 s75, v160, 11
s_waitcnt lgkmcnt(2)
v_mfma_f32_4x4x4_16b_bf16 v[152:155], v[134:135], v[140:141], 0 cbsz:4 abid:3
v_mfma_f32_4x4x4_16b_bf16 v[156:159], v[134:135], v[142:143], 0 cbsz:4 abid:3
s_mov_b32 m0, s89
s_and_b32 s80, s75, 0xfffffc00
buffer_load_dwordx4 v2, s[8:11], s80 offen lds
s_set_gpr_idx_on s66, gpr_idx(SRC2,DST)
v_fmac_f32 v16, v144, v66
v_fmac_f32 v17, v145, v66
v_fmac_f32 v18, v146, v66
v_fmac_f32 v19, v147, v66
v_fmac_f32 v20, v148, v82
v_fmac_f32 v21, v149, v82
v_fmac_f32 v22, v150, v82
v_fmac_f32 v23, v151, v82
s_set_gpr_idx_off
s_sub_u32 s53, s53, 1
s_cbranch_scc1 L_sweep_done
s_waitcnt vmcnt(4)
ds_read_b64_tr_b16 v[140:141], v3 offset:5120
ds_read_b64_tr_b16 v[142:143], v3 offset:5632
v_readlane_b32 s76, v160, 12
s_waitcnt lgkmcnt(2)
v_mfma_f32_4x4x4_16b_bf16 v[144:147], v[134:135], v[136:137], 0 cbsz:4 abid:4
v_mfma_f32_4x4x4_16b_bf16 v[148:151], v[134:135], v[138:139], 0 cbsz:4 abid:4
s_mov_b32 m0, s90
s_and_b32 s80, s76, 0xfffffc00
buffer_load_dwordx4 v2, s[8:11], s80 offen lds
v_lshl_add_u32 v162, v162, 5, v7
v_lshl_add_u32 v163, v163, 3, s101
ds_read_b64 v[128:129], v163
s_mov_b64 exec, s[82:83]
ds_read_b128 v[112:115], v162
s_mov_b64 exec, s[84:85]
ds_read_b128 v[116:119], v162
s_mov_b64 exec, -1
s_set_gpr_idx_on s67, gpr_idx(SRC2,DST)
v_fmac_f32 v16, v152, v67
v_fmac_f32 v17, v153, v67
v_fmac_f32 v18, v154, v67
v_fmac_f32 v19, v155, v67
v_fmac_f32 v20, v156, v83
v_fmac_f32 v21, v157, v83
v_fmac_f32 v22, v158, v83
v_fmac_f32 v23, v159, v83
s_set_gpr_idx_off
s_sub_u32 s53, s53, 1
s_cbranch_scc1 L_sweep_done
s_waitcnt vmcnt(4)
ds_read_b64_tr_b16 v[136:137], v3 offset:6144
ds_read_b64_tr_b16 v[138:139], v3 offset:6656
v_readlane_b32 s77, v160, 13
s_waitcnt lgkmcnt(5)
v_mfma_f32_4x4x4_16b_bf16 v[152:155], v[134:135], v[140:141], 0 cbsz:4 abid:5
v_mfma_f32_4x4x4_16b_bf16 v[156:159], v[134:135], v[142:143], 0 cbsz:4 abid:5
s_mov_b32 m0, s91
s_and_b32 s80, s77, 0xfffffc00
buffer_load_dwordx4 v2, s[8:11], s80 offen lds
s_set_gpr_idx_on s68, gpr_idx(SRC2,DST)
v_fmac_f32 v16, v144, v68
v_fmac_f32 v17, v145, v68
v_fmac_f32 v18, v146, v68
v_fmac_f32 v19, v147, v68
v_fmac_f32 v20, v148, v84
v_fmac_f32 v21, v149, v84
v_fmac_f32 v22, v150, v84
v_fmac_f32 v23, v151, v84
s_set_gpr_idx_off
s_sub_u32 s53, s53, 1
s_cbranch_scc1 L_sweep_done
s_waitcnt vmcnt(4)
ds_read_b64_tr_b16 v[140:141], v3 offset:7168
ds_read_b64_tr_b16 v[142:143], v3 offset:7680
v_readlane_b32 s78, v160, 14
s_waitcnt lgkmcnt(2)
v_mfma_f32_4x4x4_16b_bf16 v[144:147], v[134:135], v[136:137], 0 cbsz:4 abid:6
v_mfma_f32_4x4x4_16b_bf16 v[148:151], v[134:135], v[138:139], 0 cbsz:4 abid:6
s_mov_b32 m0, s92
s_and_b32 s80, s78, 0xfffffc00
buffer_load_dwordx4 v2, s[8:11], s80 offen lds
s_set_gpr_idx_on s69, gpr_idx(SRC2,DST)
v_fmac_f32 v16, v152, v69
v_fmac_f32 v17, v153, v69
v_fmac_f32 v18, v154, v69
v_fmac_f32 v19, v155, v69
v_fmac_f32 v20, v156, v85
v_fmac_f32 v21, v157, v85
v_fmac_f32 v22, v158, v85
v_fmac_f32 v23, v159, v85
s_set_gpr_idx_off
s_sub_u32 s53, s53, 1
s_cbranch_scc1 L_sweep_done
s_waitcnt vmcnt(4)
ds_read_b64_tr_b16 v[136:137], v3 offset:0
ds_read_b64_tr_b16 v[138:139], v3 offset:512
v_readlane_b32 s79, v160, 15
s_waitcnt lgkmcnt(2)
v_mfma_f32_4x4x4_16b_bf16 v[152:155], v[134:135], v[140:141], 0 cbsz:4 abid:7
v_mfma_f32_4x4x4_16b_bf16 v[156:159], v[134:135], v[142:143], 0 cbsz:4 abid:7
s_mov_b32 m0, s93
s_and_b32 s80, s79, 0xfffffc00
buffer_load_dwordx4 v2, s[8:11], s80 offen lds
s_cmp_ge_u32 s63, 16
s_cbranch_scc1 L_nowb
ds_read2_b64 v[228:231], v246 offset0:0 offset1:32
ds_read2_b64 v[232:235], v246 offset0:64 offset1:96
ds_read2_b64 v[236:239], v246 offset0:128 offset1:160
ds_read2_b64 v[240:243], v246 offset0:192 offset1:224
v_add_u32 v246, 8192, v246
s_waitcnt lgkmcnt(0)
s_set_gpr_idx_on s63, gpr_idx(DST)
v_perm_b32 v164, v230, v228, s44
v_perm_b32 v165, v234, v232, s44
v_perm_b32 v166, v238, v236, s44
v_perm_b32 v167, v242, v240, s44
v_perm_b32 v180, v230, v228, s45
v_perm_b32 v181, v234, v232, s45
v_perm_b32 v182, v238, v236, s45
v_perm_b32 v183, v242, v240, s45
v_perm_b32 v196, v231, v229, s44
v_perm_b32 v197, v235, v233, s44
v_perm_b32 v198, v239, v237, s44
v_perm_b32 v199, v243, v241, s44
v_perm_b32 v212, v231, v229, s45
v_perm_b32 v213, v235, v233, s45
v_perm_b32 v214, v239, v237, s45
v_perm_b32 v215, v243, v241, s45
s_set_gpr_idx_off
s_add_u32 s63, s63, 4
L_nowb:
s_set_gpr_idx_on s70, gpr_idx(SRC2,DST)
v_fmac_f32 v16, v144, v70
v_fmac_f32 v17, v145, v70
v_fmac_f32 v18, v146, v70
v_fmac_f32 v19, v147, v70
v_fmac_f32 v20, v148, v86
v_fmac_f32 v21, v149, v86
v_fmac_f32 v22, v150, v86
v_fmac_f32 v23, v151, v86
s_set_gpr_idx_off
s_sub_u32 s53, s53, 1
s_cbranch_scc1 L_sweep_done
s_waitcnt vmcnt(4)
ds_read_b64_tr_b16 v[140:141], v3 offset:1024
ds_read_b64_tr_b16 v[142:143], v3 offset:1536
v_readlane_b32 s64, v160, 16
s_waitcnt lgkmcnt(2)
v_mfma_f32_4x4x4_16b_bf16 v[144:147], v[134:135], v[136:137], 0 cbsz:4 abid:8
v_mfma_f32_4x4x4_16b_bf16 v[148:151], v[134:135], v[138:139], 0 cbsz:4 abid:8
s_mov_b32 m0, s86
s_and_b32 s80, s64, 0xfffffc00
buffer_load_dwordx4 v2, s[8:11], s80 offen lds
s_set_gpr_idx_on s71, gpr_idx(SRC2,DST)
v_fmac_f32 v16, v152, v71
v_fmac_f32 v17, v153, v71
v_fmac_f32 v18, v154, v71
v_fmac_f32 v19, v155, v71
v_fmac_f32 v20, v156, v87
v_fmac_f32 v21, v157, v87
v_fmac_f32 v22, v158, v87
v_fmac_f32 v23, v159, v87
s_set_gpr_idx_off
s_sub_u32 s53, s53, 1
s_cbranch_scc1 L_sweep_done
s_waitcnt vmcnt(4)
ds_read_b64_tr_b16 v[136:137], v3 offset:2048
ds_read_b64_tr_b16 v[138:139], v3 offset:2560
v_readlane_b32 s65, v160, 17
s_waitcnt lgkmcnt(2)
v_mfma_f32_4x4x4_16b_bf16 v[152:155], v[134:135], v[140:141], 0 cbsz:4 abid:9
v_mfma_f32_4x4x4_16b_bf16 v[156:159], v[134:135], v[142:143], 0 cbsz:4 abid:9
s_mov_b32 m0, s87
s_and_b32 s80, s65, 0xfffffc00
buffer_load_dwordx4 v2, s[8:11], s80 offen lds
v_dot2_f32_bf16 v130, v128, v120, 0
v_dot2_f32_bf16 v131, v128, v122, 0
v_dot2_f32_bf16 v132, v128, v124, 0
v_dot2_f32_bf16 v133, v128, v126, 0
s_set_gpr_idx_on s72, gpr_idx(SRC2,DST)
v_fmac_f32 v16, v144, v72
v_fmac_f32 v17, v145, v72
v_fmac_f32 v18, v146, v72
v_fmac_f32 v19, v147, v72
v_fmac_f32 v20, v148, v88
v_fmac_f32 v21, v149, v88
v_fmac_f32 v22, v150, v88
v_fmac_f32 v23, v151, v88
s_set_gpr_idx_off
s_sub_u32 s53, s53, 1
s_cbranch_scc1 L_sweep_done
s_waitcnt vmcnt(4)
ds_read_b64_tr_b16 v[140:141], v3 offset:3072
ds_read_b64_tr_b16 v[142:143], v3 offset:3584
v_readlane_b32 s66, v160, 18
s_waitcnt lgkmcnt(2)
v_mfma_f32_4x4x4_16b_bf16 v[144:147], v[134:135], v[136:137], 0 cbsz:4 abid:10
v_mfma_f32_4x4x4_16b_bf16 v[148:151], v[134:135], v[138:139], 0 cbsz:4 abid:10
s_mov_b32 m0, s88
s_and_b32 s80, s66, 0xfffffc00
buffer_load_dwordx4 v2, s[8:11], s80 offen lds
v_dot2_f32_bf16 v130, v129, v121, v130
v_dot2_f32_bf16 v131, v129, v123, v131
v_dot2_f32_bf16 v132, v129, v125, v132
v_dot2_f32_bf16 v133, v129, v127, v133
s_set_gpr_idx_on s73, gpr_idx(SRC2,DST)
v_fmac_f32 v16, v152, v73
v_fmac_f32 v17, v153, v73
v_fmac_f32 v18, v154, v73
v_fmac_f32 v19, v155, v73
v_fmac_f32 v20, v156, v89
v_fmac_f32 v21, v157, v89
v_fmac_f32 v22, v158, v89
v_fmac_f32 v23, v159, v89
s_set_gpr_idx_off
s_sub_u32 s53, s53, 1
s_cbranch_scc1 L_sweep_done
s_waitcnt vmcnt(4)
ds_read_b64_tr_b16 v[136:137], v3 offset:4096
ds_read_b64_tr_b16 v[138:139], v3 offset:4608
v_readlane_b32 s67, v160, 19
s_waitcnt lgkmcnt(2)
v_mfma_f32_4x4x4_16b_bf16 v[152:155], v[134:135], v[140:141], 0 cbsz:4 abid:11
v_mfma_f32_4x4x4_16b_bf16 v[156:159], v[134:135], v[142:143], 0 cbsz:4 abid:11
s_mov_b32 m0, s89
s_and_b32 s80, s67, 0xfffffc00
buffer_load_dwordx4 v2, s[8:11], s80 offen lds
s_set_gpr_idx_on s74, gpr_idx(SRC2,DST)
v_fmac_f32 v16, v144, v74
v_fmac_f32 v17, v145, v74
v_fmac_f32 v18, v146, v74
v_fmac_f32 v19, v147, v74
v_fmac_f32 v20, v148, v90
v_fmac_f32 v21, v149, v90
v_fmac_f32 v22, v150, v90
v_fmac_f32 v23, v151, v90
s_set_gpr_idx_off
s_sub_u32 s53, s53, 1
s_cbranch_scc1 L_sweep_done
s_waitcnt vmcnt(4)
ds_read_b64_tr_b16 v[140:141], v3 offset:5120
ds_read_b64_tr_b16 v[142:143], v3 offset:5632
v_readlane_b32 s68, v160, 20
s_waitcnt lgkmcnt(2)
v_mfma_f32_4x4x4_16b_bf16 v[144:147], v[134:135], v[136:137], 0 cbsz:4 abid:12
v_mfma_f32_4x4x4_16b_bf16 v[148:151], v[134:135], v[138:139], 0 cbsz:4 abid:12
s_mov_b32 m0, s90
s_and_b32 s80, s68, 0xfffffc00
buffer_load_dwordx4 v2, s[8:11], s80 offen lds
s_set_gpr_idx_on s75, gpr_idx(SRC2,DST)
v_fmac_f32 v16, v152, v75
v_fmac_f32 v17, v153, v75
v_fmac_f32 v18, v154, v75
v_fmac_f32 v19, v155, v75
v_fmac_f32 v20, v156, v91
v_fmac_f32 v21, v157, v91
v_fmac_f32 v22, v158, v91
v_fmac_f32 v23, v159, v91
s_set_gpr_idx_off
s_sub_u32 s53, s53, 1
s_cbranch_scc1 L_sweep_done
s_waitcnt vmcnt(4)
ds_read_b64_tr_b16 v[136:137], v3 offset:6144
ds_read_b64_tr_b16 v[138:139], v3 offset:6656
v_readlane_b32 s69, v160, 21
s_waitcnt lgkmcnt(2)
v_mfma_f32_4x4x4_16b_bf16 v[152:155], v[134:135], v[140:141], 0 cbsz:4 abid:13
v_mfma_f32_4x4x4_16b_bf16 v[156:159], v[134:135], v[142:143], 0 cbsz:4 abid:13
s_mov_b32 m0, s91
s_and_b32 s80, s69, 0xfffffc00
buffer_load_dwordx4 v2, s[8:11], s80 offen lds
s_set_gpr_idx_on s76, gpr_idx(SRC2,DST)
v_fmac_f32 v16, v144, v76
v_fmac_f32 v17, v145, v76
v_fmac_f32 v18, v146, v76
v_fmac_f32 v19, v147, v76
v_fmac_f32 v20, v148, v92
v_fmac_f32 v21, v149, v92
v_fmac_f32 v22, v150, v92
v_fmac_f32 v23, v151, v92
s_set_gpr_idx_off
s_sub_u32 s53, s53, 1
s_cbranch_scc1 L_sweep_done
s_waitcnt vmcnt(4)
ds_read_b64_tr_b16 v[140:141], v3 offset:7168
ds_read_b64_tr_b16 v[142:143], v3 offset:7680
v_readlane_b32 s70, v160, 22
s_waitcnt lgkmcnt(2)
v_mfma_f32_4x4x4_16b_bf16 v[144:147], v[134:135], v[136:137], 0 cbsz:4 abid:14
v_mfma_f32_4x4x4_16b_bf16 v[148:151], v[134:135], v[138:139], 0 cbsz:4 abid:14
s_mov_b32 m0, s92
s_and_b32 s80, s70, 0xfffffc00
buffer_load_dwordx4 v2, s[8:11], s80 offen lds
s_set_gpr_idx_on s77, gpr_idx(SRC2,DST)
v_fmac_f32 v16, v152, v77
v_fmac_f32 v17, v153, v77
v_fmac_f32 v18, v154, v77
v_fmac_f32 v19, v155, v77
v_fmac_f32 v20, v156, v93
v_fmac_f32 v21, v157, v93
v_fmac_f32 v22, v158, v93
v_fmac_f32 v23, v159, v93
s_set_gpr_idx_off
s_sub_u32 s53, s53, 1
s_cbranch_scc1 L_sweep_done
s_waitcnt vmcnt(4)
ds_read_b64_tr_b16 v[136:137], v3 offset:0
ds_read_b64_tr_b16 v[138:139], v3 offset:512
v_readlane_b32 s71, v160, 23
s_waitcnt lgkmcnt(2)
v_mfma_f32_4x4x4_16b_bf16 v[152:155], v[134:135], v[140:141], 0 cbsz:4 abid:15
v_mfma_f32_4x4x4_16b_bf16 v[156:159], v[134:135], v[142:143], 0 cbsz:4 abid:15
s_mov_b32 m0, s93
s_and_b32 s80, s71, 0xfffffc00
buffer_load_dwordx4 v2, s[8:11], s80 offen lds
s_set_gpr_idx_on s78, gpr_idx(SRC2,DST)
v_fmac_f32 v16, v144, v78
v_fmac_f32 v17, v145, v78
v_fmac_f32 v18, v146, v78
v_fmac_f32 v19, v147, v78
v_fmac_f32 v20, v148, v94
v_fmac_f32 v21, v149, v94
v_fmac_f32 v22, v150, v94
v_fmac_f32 v23, v151, v94
s_set_gpr_idx_off
s_sub_u32 s53, s53, 1
s_cbranch_scc1 L_sweep_done
s_waitcnt vmcnt(4)
ds_read_b64_tr_b16 v[140:141], v3 offset:1024
ds_read_b64_tr_b16 v[142:143], v3 offset:1536
v_readlane_b32 s72, v160, 24
s_waitcnt lgkmcnt(2)
v_cvt_pk_bf16_f32 v134, v130, v131
v_cvt_pk_bf16_f32 v135, v132, v133
v_mov_b32 v160, v161
s_nop 0
v_mfma_f32_4x4x4_16b_bf16 v[144:147], v[134:135], v[136:137], 0 cbsz:4 abid:0
v_mfma_f32_4x4x4_16b_bf16 v[148:151], v[134:135], v[138:139], 0 cbsz:4 abid:0
s_mov_b32 m0, s86
s_and_b32 s80, s72, 0xfffffc00
buffer_load_dwordx4 v2, s[8:11], s80 offen lds
s_set_gpr_idx_on s79, gpr_idx(SRC2,DST)
v_fmac_f32 v16, v152, v79
v_fmac_f32 v17, v153, v79
v_fmac_f32 v18, v154, v79
v_fmac_f32 v19, v155, v79
v_fmac_f32 v20, v156, v95
v_fmac_f32 v21, v157, v95
v_fmac_f32 v22, v158, v95
v_fmac_f32 v23, v159, v95
s_set_gpr_idx_off
s_sub_u32 s53, s53, 1
s_cbranch_scc1 L_sweep_done
v_mfma_f32_32x32x16_bf16 v[64:79], v[112:115], v[96:99], 0
v_mfma_f32_32x32x16_bf16 v[64:79], v[116:119], v[100:103], v[64:79]
v_mfma_f32_32x32x16_bf16 v[80:95], v[112:115], v[104:107], 0
v_mfma_f32_32x32x16_bf16 v[80:95], v[116:119], v[108:111], v[80:95]
s_branch L_loop
L_sweep_done:
s_cmp_lg_u32 s56, 0
s_cbranch_scc1 L_slownext
L_epi:
s_setprio 0
v_cvt_pk_bf16_f32 v64, v16, v17
v_cvt_pk_bf16_f32 v65, v18, v19
v_cvt_pk_bf16_f32 v66, v20, v21
v_cvt_pk_bf16_f32 v67, v22, v23
v_cvt_pk_bf16_f32 v68, v24, v25
v_cvt_pk_bf16_f32 v69, v26, v27
v_cvt_pk_bf16_f32 v70, v28, v29
v_cvt_pk_bf16_f32 v71, v30, v31
v_cvt_pk_bf16_f32 v72, v32, v33
v_cvt_pk_bf16_f32 v73, v34, v35
v_cvt_pk_bf16_f32 v74, v36, v37
v_cvt_pk_bf16_f32 v75, v38, v39
v_cvt_pk_bf16_f32 v76, v40, v41
v_cvt_pk_bf16_f32 v77, v42, v43
v_cvt_pk_bf16_f32 v78, v44, v45
v_cvt_pk_bf16_f32 v79, v46, v47
v_cvt_pk_bf16_f32 v80, v48, v49
v_cvt_pk_bf16_f32 v81, v50, v51
v_cvt_pk_bf16_f32 v82, v52, v53
v_cvt_pk_bf16_f32 v83, v54, v55
s_waitcnt vmcnt(0)
ds_write_b64 v244, v[64:65] offset:0
ds_write_b64 v244, v[66:67] offset:3072
ds_write_b64 v244, v[68:69] offset:8
ds_write_b64 v244, v[70:71] offset:3080
ds_write_b64 v244, v[72:73] offset:16
ds_write_b64 v244, v[74:75] offset:3088
ds_write_b64 v244, v[76:77] offset:24
ds_write_b64 v244, v[78:79] offset:3096
ds_write_b64 v244, v[80:81] offset:32
ds_write_b64 v244, v[82:83] offset:3104
s_mov_b64 exec, 1
ds_add_u32 v247, v10
s_mov_b64 exec, -1
s_mul_i32 s80, s2, 40960
ds_read_b32 v12, v248 offset:0
ds_read_b32 v13, v248 offset:8
ds_read_b32 v14, v248 offset:16
s_cmp_lt_u32 s63, 16
s_cbranch_scc1 L_wfin
L_gw:
ds_read_b32 v15, v247
s_waitcnt lgkmcnt(0)
v_readfirstlane_b32 s43, v15
s_cmp_ge_u32 s43, 4
s_cbranch_scc1 L_gok
s_sleep 1
s_branch L_gw
L_gok:
ds_read_b64_tr_b16 v[16:17], v245 offset:0
ds_read_b64_tr_b16 v[18:19], v245 offset:192
ds_read_b64_tr_b16 v[20:21], v245 offset:1536
ds_read_b64_tr_b16 v[22:23], v245 offset:1728
ds_read_b64_tr_b16 v[24:25], v245 offset:3072
ds_read_b64_tr_b16 v[26:27], v245 offset:3264
ds_read_b64_tr_b16 v[28:29], v245 offset:4608
ds_read_b64_tr_b16 v[30:31], v245 offset:4800
ds_read_b64_tr_b16 v[32:33], v245 offset:16
ds_read_b64_tr_b16 v[34:35], v245 offset:208
ds_read_b64_tr_b16 v[36:37], v245 offset:1552
ds_read_b64_tr_b16 v[38:39], v245 offset:1744
ds_read_b64_tr_b16 v[40:41], v245 offset:3088
ds_read_b64_tr_b16 v[42:43], v245 offset:3280
ds_read_b64_tr_b16 v[44:45], v245 offset:4624
ds_read_b64_tr_b16 v[46:47], v245 offset:4816
v_lshl_add_u32 v12, v12, 10, v249
v_lshl_add_u32 v13, v13, 10, v249
v_lshl_add_u32 v14, v14, 10, v249
s_waitcnt lgkmcnt(8)
ds_read_b64_tr_b16 v[48:49], v245 offset:32
ds_read_b64_tr_b16 v[50:51], v245 offset:224
ds_read_b64_tr_b16 v[52:53], v245 offset:1568
ds_read_b64_tr_b16 v[54:55], v245 offset:1760
ds_read_b64_tr_b16 v[56:57], v245 offset:3104
ds_read_b64_tr_b16 v[58:59], v245 offset:3296
ds_read_b64_tr_b16 v[60:61], v245 offset:4640
ds_read_b64_tr_b16 v[62:63], v245 offset:4832
v_mfma_f32_16x16x32_bf16 v[64:67], v[16:19], v[164:167], 0
v_mfma_f32_16x16x32_bf16 v[68:71], v[16:19], v[180:183], 0
v_mfma_f32_16x16x32_bf16 v[72:75], v[16:19], v[196:199], 0
v_mfma_f32_16x16x32_bf16 v[76:79], v[16:19], v[212:215], 0
v_mfma_f32_16x16x32_bf16 v[64:67], v[20:23], v[168:171], v[64:67]
v_mfma_f32_16x16x32_bf16 v[68:71], v[20:23], v[184:187], v[68:71]
v_mfma_f32_16x16x32_bf16 v[72:75], v[20:23], v[200:203], v[72:75]
v_mfma_f32_16x16x32_bf16 v[76:79], v[20:23], v[216:219], v[76:79]
v_mfma_f32_16x16x32_bf16 v[64:67], v[24:27], v[172:175], v[64:67]
v_mfma_f32_16x16x32_bf16 v[68:71], v[24:27], v[188:191], v[68:71]
v_mfma_f32_16x16x32_bf16 v[72:75], v[24:27], v[204:207], v[72:75]
v_mfma_f32_16x16x32_bf16 v[76:79], v[24:27], v[220:223], v[76:79]
v_mfma_f32_16x16x32_bf16 v[64:67], v[28:31], v[176:179], v[64:67]
v_mfma_f32_16x16x32_bf16 v[68:71], v[28:31], v[192:195], v[68:71]
v_mfma_f32_16x16x32_bf16 v[72:75], v[28:31], v[208:211], v[72:75]
v_mfma_f32_16x16x32_bf16 v[76:79], v[28:31], v[224:227], v[76:79]
s_waitcnt lgkmcnt(8)
v_mfma_f32_16x16x32_bf16 v[80:83], v[32:35], v[164:167], 0
v_mfma_f32_16x16x32_bf16 v[84:87], v[32:35], v[180:183], 0
v_mfma_f32_16x16x32_bf16 v[88:91], v[32:35], v[196:199], 0
v_mfma_f32_16x16x32_bf16 v[92:95], v[32:35], v[212:215], 0
v_mfma_f32_16x16x32_bf16 v[80:83], v[36:39], v[168:171], v[80:83]
v_mfma_f32_16x16x32_bf16 v[84:87], v[36:39], v[184:187], v[84:87]
v_mfma_f32_16x16x32_bf16 v[88:91], v[36:39], v[200:203], v[88:91]
v_mfma_f32_16x16x32_bf16 v[92:95], v[36:39], v[216:219], v[92:95]
v_cvt_pk_bf16_f32 v112, v64, v68
v_cvt_pk_bf16_f32 v113, v72, v76
buffer_store_dwordx2 v[112:113], v12, s[24:27], s80 offen offset:0 sc0 sc1
v_mfma_f32_16x16x32_bf16 v[80:83], v[40:43], v[172:175], v[80:83]
v_mfma_f32_16x16x32_bf16 v[84:87], v[40:43], v[188:191], v[84:87]
v_cvt_pk_bf16_f32 v114, v65, v69
v_cvt_pk_bf16_f32 v115, v73, v77
buffer_store_dwordx2 v[114:115], v12, s[24:27], s80 offen offset:256 sc0 sc1
v_mfma_f32_16x16x32_bf16 v[88:91], v[40:43], v[204:207], v[88:91]
v_mfma_f32_16x16x32_bf16 v[92:95], v[40:43], v[220:223], v[92:95]
v_cvt_pk_bf16_f32 v116, v66, v70
v_cvt_pk_bf16_f32 v117, v74, v78
buffer_store_dwordx2 v[116:117], v12, s[24:27], s80 offen offset:512 sc0 sc1
v_mfma_f32_16x16x32_bf16 v[80:83], v[44:47], v[176:179], v[80:83]
v_mfma_f32_16x16x32_bf16 v[84:87], v[44:47], v[192:195], v[84:87]
v_cvt_pk_bf16_f32 v118, v67, v71
v_cvt_pk_bf16_f32 v119, v75, v79
buffer_store_dwordx2 v[118:119], v12, s[24:27], s80 offen offset:768 sc0 sc1
v_mfma_f32_16x16x32_bf16 v[88:91], v[44:47], v[208:211], v[88:91]
v_mfma_f32_16x16x32_bf16 v[92:95], v[44:47], v[224:227], v[92:95]
s_cmp_lg_u32 s62, 0
s_cbranch_scc1 L_epi2
s_waitcnt lgkmcnt(0)
v_mfma_f32_16x16x32_bf16 v[96:99], v[48:51], v[164:167], 0
v_mfma_f32_16x16x32_bf16 v[100:103], v[48:51], v[180:183], 0
v_mfma_f32_16x16x32_bf16 v[104:107], v[48:51], v[196:199], 0
v_mfma_f32_16x16x32_bf16 v[108:111], v[48:51], v[212:215], 0
v_mfma_f32_16x16x32_bf16 v[96:99], v[52:55], v[168:171], v[96:99]
v_mfma_f32_16x16x32_bf16 v[100:103], v[52:55], v[184:187], v[100:103]
v_mfma_f32_16x16x32_bf16 v[104:107], v[52:55], v[200:203], v[104:107]
v_mfma_f32_16x16x32_bf16 v[108:111], v[52:55], v[216:219], v[108:111]
v_cvt_pk_bf16_f32 v120, v80, v84
v_cvt_pk_bf16_f32 v121, v88, v92
buffer_store_dwordx2 v[120:121], v13, s[24:27], s80 offen offset:0 sc0 sc1
v_mfma_f32_16x16x32_bf16 v[96:99], v[56:59], v[172:175], v[96:99]
v_mfma_f32_16x16x32_bf16 v[100:103], v[56:59], v[188:191], v[100:103]
v_cvt_pk_bf16_f32 v122, v81, v85
v_cvt_pk_bf16_f32 v123, v89, v93
buffer_store_dwordx2 v[122:123], v13, s[24:27], s80 offen offset:256 sc0 sc1
v_mfma_f32_16x16x32_bf16 v[104:107], v[56:59], v[204:207], v[104:107]
v_mfma_f32_16x16x32_bf16 v[108:111], v[56:59], v[220:223], v[108:111]
v_cvt_pk_bf16_f32 v124, v82, v86
v_cvt_pk_bf16_f32 v125, v90, v94
buffer_store_dwordx2 v[124:125], v13, s[24:27], s80 offen offset:512 sc0 sc1
v_mfma_f32_16x16x32_bf16 v[96:99], v[60:63], v[176:179], v[96:99]
v_mfma_f32_16x16x32_bf16 v[100:103], v[60:63], v[192:195], v[100:103]
v_cvt_pk_bf16_f32 v126, v83, v87
v_cvt_pk_bf16_f32 v127, v91, v95
buffer_store_dwordx2 v[126:127], v13, s[24:27], s80 offen offset:768 sc0 sc1
v_mfma_f32_16x16x32_bf16 v[104:107], v[60:63], v[208:211], v[104:107]
v_mfma_f32_16x16x32_bf16 v[108:111], v[60:63], v[224:227], v[108:111]
s_nop 7
v_cvt_pk_bf16_f32 v128, v96, v100
v_cvt_pk_bf16_f32 v129, v104, v108
buffer_store_dwordx2 v[128:129], v14, s[24:27], s80 offen offset:0 sc0 sc1
v_cvt_pk_bf16_f32 v130, v97, v101
v_cvt_pk_bf16_f32 v131, v105, v109
buffer_store_dwordx2 v[130:131], v14, s[24:27], s80 offen offset:256 sc0 sc1
v_cvt_pk_bf16_f32 v132, v98, v102
v_cvt_pk_bf16_f32 v133, v106, v110
buffer_store_dwordx2 v[132:133], v14, s[24:27], s80 offen offset:512 sc0 sc1
v_cvt_pk_bf16_f32 v134, v99, v103
v_cvt_pk_bf16_f32 v135, v107, v111
buffer_store_dwordx2 v[134:135], v14, s[24:27], s80 offen offset:768 sc0 sc1
s_branch L_epi3
L_epi2:
s_nop 7
v_cvt_pk_bf16_f32 v120, v80, v84
v_cvt_pk_bf16_f32 v121, v88, v92
buffer_store_dwordx2 v[120:121], v13, s[24:27], s80 offen offset:0 sc0 sc1
v_cvt_pk_bf16_f32 v122, v81, v85
v_cvt_pk_bf16_f32 v123, v89, v93
buffer_store_dwordx2 v[122:123], v13, s[24:27], s80 offen offset:256 sc0 sc1
v_cvt_pk_bf16_f32 v124, v82, v86
v_cvt_pk_bf16_f32 v125, v90, v94
buffer_store_dwordx2 v[124:125], v13, s[24:27], s80 offen offset:512 sc0 sc1
v_cvt_pk_bf16_f32 v126, v83, v87
v_cvt_pk_bf16_f32 v127, v91, v95
buffer_store_dwordx2 v[126:127], v13, s[24:27], s80 offen offset:768 sc0 sc1
L_epi3:
L_main_end:
s_endpgm
L_wfin:
ds_read2_b64 v[228:231], v246 offset0:0 offset1:32
ds_read2_b64 v[232:235], v246 offset0:64 offset1:96
ds_read2_b64 v[236:239], v246 offset0:128 offset1:160
ds_read2_b64 v[240:243], v246 offset0:192 offset1:224
v_add_u32 v246, 8192, v246
s_waitcnt lgkmcnt(0)
s_set_gpr_idx_on s63, gpr_idx(DST)
v_perm_b32 v164, v230, v228, s44
v_perm_b32 v165, v234, v232, s44
v_perm_b32 v166, v238, v236, s44
v_perm_b32 v167, v242, v240, s44
v_perm_b32 v180, v230, v228, s45
v_perm_b32 v181, v234, v232, s45
v_perm_b32 v182, v238, v236, s45
v_perm_b32 v183, v242, v240, s45
v_perm_b32 v196, v231, v229, s44
v_perm_b32 v197, v235, v233, s44
v_perm_b32 v198, v239, v237, s44
v_perm_b32 v199, v243, v241, s44
v_perm_b32 v212, v231, v229, s45
v_perm_b32 v213, v235, v233, s45
v_perm_b32 v214, v239, v237, s45
v_perm_b32 v215, v243, v241, s45
s_set_gpr_idx_off
s_add_u32 s63, s63, 4
s_cmp_lt_u32 s63, 16
s_cbranch_scc1 L_wfin
s_branch L_gw
L_slownext:
s_add_u32 s55, s55, 1
s_cmp_ge_u32 s55, 1250
s_cbranch_scc1 L_epi
s_branch L_slowload
L_goslow:
s_mov_b32 s56, 1
L_slowload:
s_waitcnt vmcnt(0) lgkmcnt(0)
s_barrier
s_mul_i32 s80, s3, 1280
s_add_u32 s80, s80, 111616
v_lshl_add_u32 v4, v1, 3, s80
s_add_u32 s80, s80, 4
v_lshrrev_b32 v6, 2, v1
v_lshl_add_u32 v6, v6, 3, s80
v_bfe_u32 v12, v1, 3, 2
v_and_b32 v13, 3, v1
v_lshl_add_u32 v12, v12, 2, v13
v_lshl_add_u32 v5, v12, 3, s80
s_mul_i32 s80, s55, 128
v_add_u32 v88, s80, v0
v_lshlrev_b32 v151, 2, v88
v_lshlrev_b32 v152, 3, v88
s_mov_b32 s28, s36
s_mov_b32 s29, s37
s_mov_b32 s30, 640000
s_mov_b32 s31, 0x20000
buffer_load_dword v149, v151, s[28:31], 0 offen
s_mov_b32 s28, s34
s_mov_b32 s29, s35
s_mov_b32 s30, 640000
s_mov_b32 s31, 0x20000
buffer_load_dword v150, v151, s[28:31], 0 offen
buffer_load_dwordx2 v[228:229], v152, s[16:19], 0 offen
v_mov_b64 v[128:129], 0
v_mov_b64 v[130:131], 0
v_min_u32 v134, 399, v0
v_lshlrev_b32 v134, 4, v134
v_add_u32 v134, 121856, v134
ds_write_b128 v134, v[128:131]
v_lshlrev_b32 v133, 2, v1
v_mov_b32 v132, 16777215
v_add_u32 v133, s52, v133
ds_write_b32 v133, v132 offset:0
ds_write_b32 v133, v132 offset:256
ds_write_b32 v133, v132 offset:512
v_mov_b32 v136, 10240040
v_mov_b32 v137, 0
v_mov_b64 v[138:139], v[136:137]
v_lshlrev_b32 v135, 4, v0
v_add_u32 v135, 111616, v135
ds_write_b128 v135, v[136:139]
ds_write_b128 v135, v[136:139] offset:2048
v_mov_b32 v11, 64
s_mul_i32 s96, s3, 4608
s_add_u32 s96, s96, 65536
s_mul_i32 s97, s3, 1152
s_add_u32 s97, s97, 102400
v_and_b32 v92, 1, v1
v_lshlrev_b32 v92, 4, v92
v_lshrrev_b32 v94, 1, v1
v_lshl_add_u32 v94, v94, 2, s52
s_mul_i32 s80, s2, 40
s_waitcnt vmcnt(0)
v_subrev_u32 v149, s80, v149
v_lshl_or_b32 v150, v150, 18, 1
v_lshl_or_b32 v230, v149, 12, v150
v_cmp_gt_u32 vcc, 40, v149
s_movk_i32 s80, 128
v_cmp_gt_u32 s[40:41], s80, v0
s_nop 1
s_and_b64 vcc, vcc, s[40:41]
s_nop 1
v_cndmask_b32 v230, 0, v230, vcc
s_mov_b32 s57, 0
s_waitcnt lgkmcnt(0)
s_barrier
v_and_b32 v128, 1, v230
v_cmp_ne_u32 s[64:65], 0, v128
v_bfe_u32 v130, v230, 1, 10
v_add_u32 v130, v130, v88
v_mov_b32 v80, s57
v_mbcnt_lo_u32_b32 v80, s64, v80
v_mbcnt_hi_u32_b32 v80, s65, v80
s_bcnt1_i32_b64 s80, s[64:65]
s_add_u32 s57, s57, s80
v_lshl_add_u32 v132, v80, 2, s52
v_min_u32 v80, 143, v80
v_lshl_add_u32 v134, v80, 3, s97
s_mov_b64 exec, s[64:65]
ds_write_b32 v132, v130
ds_write_b64 v134, v[228:229]
s_mov_b64 exec, -1
ds_read_b32 v144, v94 offset:0
ds_read_b32 v145, v94 offset:128
v_bfe_u32 v136, v230, 12, 6
v_lshrrev_b32 v64, 26, v230
v_mad_u32_u24 v64, v136, 40, v64
v_lshl_add_u32 v64, v64, 2, s100
v_lshl_add_u32 v136, v136, 2, s100
v_add_u32 v80, s59, v80
s_mov_b64 exec, s[64:65]
ds_add_rtn_u32 v72, v64, v10
s_mov_b64 exec, -1
s_waitcnt lgkmcnt(0)
s_cmp_le_u32 s57, 0
s_cbranch_scc1 L_rd_s0
s_add_u32 m0, s96, 0
v_lshl_add_u32 v154, v144, 5, v92
buffer_load_dwordx4 v154, s[12:15], 0 offen lds
L_rd_s0:
s_cmp_le_u32 s57, 32
s_cbranch_scc1 L_rd_s1
s_add_u32 m0, s96, 1024
v_lshl_add_u32 v154, v145, 5, v92
buffer_load_dwordx4 v154, s[12:15], 0 offen lds
L_rd_s1:
s_waitcnt lgkmcnt(0)
s_barrier
v_lshlrev_b32 v128, 2, v1
v_add_u32 v128, 121856, v128
s_lshl_b32 s80, s3, 5
s_add_u32 s80, s80, 128512
v_mov_b32 v129, s80
ds_read_b128 v[132:135], v129
ds_read_b32 v136, v129 offset:16
s_waitcnt lgkmcnt(0)
s_movk_i32 s80, 160
v_mad_u32_u24 v132, v132, s80, v128
ds_read_b32 v138, v132
v_mad_u32_u24 v133, v133, s80, v128
ds_read_b32 v139, v133
v_mad_u32_u24 v134, v134, s80, v128
ds_read_b32 v140, v134
v_mad_u32_u24 v135, v135, s80, v128
ds_read_b32 v141, v135
v_mad_u32_u24 v136, v136, s80, v128
ds_read_b32 v142, v136
s_mul_i32 s80, s3, 160
s_add_u32 s80, s80, 13952
s_waitcnt lgkmcnt(0)
v_add3_u32 v128, v138, v139, v140
v_add3_u32 v128, v128, v141, v142
v_mov_b32 v129, v128
s_nop 1
v_add_u32_dpp v129, v129, v129 row_shr:1 row_mask:0xf bank_mask:0xf bound_ctrl:0
s_nop 1
v_add_u32_dpp v129, v129, v129 row_shr:2 row_mask:0xf bank_mask:0xf bound_ctrl:0
s_nop 1
v_add_u32_dpp v129, v129, v129 row_shr:4 row_mask:0xf bank_mask:0xf bound_ctrl:0
s_nop 1
v_add_u32_dpp v129, v129, v129 row_shr:8 row_mask:0xf bank_mask:0xf bound_ctrl:0
s_nop 1
v_add_u32_dpp v129, v129, v129 row_bcast:15 row_mask:0xa bank_mask:0xf
s_nop 1
v_add_u32_dpp v129, v129, v129 row_bcast:31 row_mask:0xc bank_mask:0xf
s_nop 0
v_readlane_b32 s54, v129, 39
v_sub_u32 v129, v129, v128
v_add_u32 v129, s80, v129
s_mov_b32 s80, 0x1000000
s_mov_b32 exec_hi, 0xff
ds_write_b32 v132, v129
v_add3_u32 v129, v129, v138, s80
ds_write_b32 v133, v129
v_add3_u32 v129, v129, v139, s80
ds_write_b32 v134, v129
v_add3_u32 v129, v129, v140, s80
ds_write_b32 v135, v129
v_add3_u32 v129, v129, v141, s80
ds_write_b32 v136, v129
s_mov_b32 exec_hi, -1
s_waitcnt lgkmcnt(0)
s_barrier
ds_read_b32 v64, v64
v_lshrrev_b32 v128, 18, v230
v_lshlrev_b32 v128, 10, v128
v_mov_b32 v129, v80
s_waitcnt lgkmcnt(0)
v_lshrrev_b32 v157, 21, v64
v_or_b32 v128, v128, v157
v_and_b32 v64, 0xffffff, v64
v_add_lshl_u32 v64, v72, v64, 3
s_mov_b64 exec, s[64:65]
ds_write_b64 v64, v[128:129]
s_mov_b64 exec, -1
s_waitcnt lgkmcnt(0)
s_barrier
s_branch L_sweep
.section .rodata,"a"
.p2align 6
.amdhsa_kernel gather_scatter__tensor_product_equiv_mace__graph_kernel
  .amdhsa_next_free_vgpr 252
  .amdhsa_next_free_sgpr 102
  .amdhsa_accum_offset 252
  .amdhsa_group_segment_fixed_size 0
  .amdhsa_kernarg_size 88
  .amdhsa_user_sgpr_count 2
  .amdhsa_user_sgpr_kernarg_segment_ptr 1
  .amdhsa_system_sgpr_workgroup_id_x 1
  .amdhsa_float_denorm_mode_32 3
.end_amdhsa_kernel
```
